```python
import torch

def _softmax(x, axis=-1):
    return torch.softmax(x, dim=axis)
def _gelu(x):
    return torch.nn.functional.gelu(x, approximate="tanh")
def _silu(x):
    return torch.nn.functional.silu(x)
def _sigmoid(x):
    return torch.sigmoid(x)
def _layernorm(x, axis=-1, eps=1e-5):
    m = x.mean(dim=axis, keepdim=True)
    v = x.var(dim=axis, keepdim=True, unbiased=False)
    return (x - m) / torch.sqrt(v + eps)
def _scatter_add(tgt, idx, src, axis=0):
    return tgt.clone().index_add_(axis, idx, src)
def _segment_sum(src, seg, n):
    out = torch.zeros((n,) + src.shape[1:], dtype=src.dtype)
    return out.index_add_(0, seg, src)
def _pad(x, pw):
    flat = tuple(v for pair in reversed(pw) for v in pair)
    return torch.nn.functional.pad(x, flat)

kernel_name = 'sequential_preLN__compressed_kv_cla__moe_arch_mod__decode'

def setup_inputs():

    _w = (lambda a: (lambda t: t.to(torch.bfloat16) if t.is_floating_point() else t)(torch.as_tensor(a)))
    def _A_setup():
        B, H, Sq, Sk, D, M = 1, 32, 1, 8192, 128, 512
        Dc = 4 * D
        return {
            "x": _w((lambda *s: torch.randn(*s, dtype=torch.bfloat16) * 0.05)(B, Sq, M)),
            "c_kv": _w((lambda *s: torch.randn(*s, dtype=torch.bfloat16) * 0.4)(B, Sk, Dc)),
            "w_q": _w((lambda *s: torch.randn(*s, dtype=torch.bfloat16) * 3.2)(M, H, D) * (M ** -0.5)),
            "w_uk": _w((lambda *s: torch.randn(*s, dtype=torch.bfloat16) * 3.2)(Dc, H, D) * (Dc ** -0.5)),
            "w_uv": _w((lambda *s: torch.randn(*s, dtype=torch.bfloat16) * 0.4)(Dc, H, D) * (Dc ** -0.5)),
            "w_o": _w((lambda *s: torch.randn(*s, dtype=torch.bfloat16) * 0.4)(H, D, M) * ((H * D) ** -0.5)),
        }
    _A_in = _A_setup()

    def _B_setup():
        B, S, D, F, C = 1, 1, 512, 1376, 1
        return {
            "x": _w((lambda *s: torch.randn(*s, dtype=torch.bfloat16) * 0.05)(B, S, D)),
            "w_r": _w((lambda *s: torch.randn(*s, dtype=torch.bfloat16) * 0.1)(D)),
            "w_gate": _w((lambda *s: torch.randn(*s, dtype=torch.bfloat16) * 0.05)(D, F)),
            "w_up": _w((lambda *s: torch.randn(*s, dtype=torch.bfloat16) * 0.05)(D, F)),
            "w_down": _w((lambda *s: torch.randn(*s, dtype=torch.bfloat16) * 0.05)(F, D)),
        }
    _B_in = _B_setup()

    return {
        "A_x": _A_in["x"],
        "A_c_kv": _A_in["c_kv"],
        "A_w_q": _A_in["w_q"],
        "A_w_uk": _A_in["w_uk"],
        "A_w_uv": _A_in["w_uv"],
        "A_w_o": _A_in["w_o"],
        "B_x": _B_in["x"],
        "B_w_r": _B_in["w_r"],
        "B_w_gate": _B_in["w_gate"],
        "B_w_up": _B_in["w_up"],
        "B_w_down": _B_in["w_down"],
    }

def reference(A_x, A_c_kv, A_w_q, A_w_uk, A_w_uv, A_w_o, B_x, B_w_r, B_w_gate, B_w_up, B_w_down):
    def _A_ref(x, c_kv, w_q, w_uk, w_uv, w_o):
        B, Sq, M = x.shape[0], x.shape[1], x.shape[2]
        Sk = c_kv.shape[1]
        H, D = w_q.shape[1], w_q.shape[2]
        q = torch.einsum("bqm,mhd->bhqd", x, w_q)
        k = torch.einsum("bkc,chd->bhkd", c_kv, w_uk)
        v = torch.einsum("bkc,chd->bhkd", c_kv, w_uv)
        scores = torch.einsum("bhqd,bhkd->bhqk", q, k) * (D ** -0.5)
        off = Sk - Sq
        qi = torch.arange(Sq)[:, None]
        kj = torch.arange(Sk)[None, :]
        cmask = kj <= (qi + off)
        scores = torch.where(cmask[None, None], scores, -1e9)
        p = _softmax(scores, axis=-1)
        ctx = torch.einsum("bhqk,bhkd->bhqd", p, v)
        return torch.einsum("bhqd,hdm->bqm", ctx, w_o)

    def _B_ref(x, w_r, w_gate, w_up, w_down):
        B, S, D = x.shape
        C = 1
        r = x @ w_r
        idx = torch.argsort(-r, axis=-1)[:, :C]
        idx_e = (lambda x, n, axis: torch.repeat_interleave(x, n, dim=axis))(idx.reshape(B, C, 1), D, axis=2)
        x_sel = (lambda x, i, axis: torch.take_along_dim(x, i, dim=axis))(x, idx_e, axis=1)
        g = _silu(x_sel @ w_gate)
        u = x_sel @ w_up
        y = (g * u) @ w_down
        r_sel = _sigmoid((lambda x, i, axis: torch.take_along_dim(x, i, dim=axis))(r, idx, axis=1))
        y = y * r_sel.reshape(B, C, 1)
        b_off = (torch.arange(B) * S).reshape(B, 1)
        flat_idx = (idx + b_off).reshape(B * C)
        zero = (x * 0.0).reshape(B * S, D)
        upd = _scatter_add(zero, flat_idx, y.reshape(B * C, D), axis=0)
        return x + upd.reshape(B, S, D)

    x = A_x
    h = x + _A_ref(_layernorm(x, axis=-1), A_c_kv, A_w_q, A_w_uk, A_w_uv, A_w_o)
    h2 = h + _B_ref(_layernorm(h, axis=-1), B_w_r, B_w_gate, B_w_up, B_w_down)
    return h2
```

```asm
; @launch grid=(256,1,1) block=(256,1,1) lds=158208
.amdgcn_target "amdgcn-amd-amdhsa--gfx950"
.text
.globl sequential_preLN__compressed_kv_cla__moe_arch_mod__decode_kernel
.p2align 12
.p2align 8
.type sequential_preLN__compressed_kv_cla__moe_arch_mod__decode_kernel,@function
sequential_preLN__compressed_kv_cla__moe_arch_mod__decode_kernel:
    s_load_dwordx16 s[4:19], s[0:1], 0
    v_lshrrev_b32 v12, 6, v0
    s_lshr_b32 s33, s2, 3
    v_readfirstlane_b32 s34, v12
    s_load_dwordx8 s[20:27], s[0:1], 64
    s_load_dwordx2 s[30:31], s[0:1], 104
    s_cmp_ge_u32 s33, 32
    s_cbranch_scc1 L_end
    s_getpc_b64 s[50:51]
L_pc:
    s_lshl_b32 s38, s33, 10
    v_lshl_add_u32 v12, v0, 2, s38
    v_min_u32 v12, L_code_end - L_pc - 4, v12
    global_load_dword v255, v12, s[50:51]
    v_and_b32 v1, 63, v0
    s_and_b32 s32, s2, 7
    s_lshr_b32 s36, s33, 1
    s_lshr_b32 s38, s33, 3
    s_lshl2_add_u32 s35, s32, s38
    s_and_b32 s38, s36, 3
    s_lshl2_add_u32 s38, s38, s34
    s_lshl_b32 s38, s38, 5
    v_lshrrev_b32 v14, 3, v1
    v_and_b32 v15, 7, v1
    v_lshl_add_u32 v16, v14, 2, s38
    s_and_b32 s39, s33, 1
    s_lshl1_add_u32 s39, s35, s39
    s_lshl_b32 s39, s39, 7
    v_lshl_add_u32 v17, v15, 4, s39
    v_lshl_add_u32 v76, v16, 13, v17
    v_lshlrev_b32 v16, 1, v16
    v_lshlrev_b32 v5, 4, v1
    v_and_b32 v2, 15, v1
    v_lshrrev_b32 v3, 4, v1
    s_movk_i32 s3, 0x2000
    s_lshr_b32 s39, s36, 1
    s_lshl3_add_u32 s39, s32, s39
    s_lshl2_add_u32 s39, s39, s34
    s_lshl_b32 s52, s39, 15
    s_and_b32 s48, s36, 1
    s_mul_i32 s48, s48, 10240
    s_add_u32 s48, s48, s52
    v_add_u32 v77, s48, v5
    s_mul_i32 m0, s34, 33792
    s_lshl2_add_u32 s58, s32, s34
    s_lshl_b32 s59, s36, 5
    s_waitcnt lgkmcnt(0)
    global_load_dwordx4 v[20:23], v5, s[4:5]
    global_load_dwordx2 v[24:25], v16, s[4:5]
    global_load_dwordx4 v[28:31], v76, s[8:9] nt
    v_add_u32 v76, s3, v76
    global_load_dwordx4 v[32:35], v76, s[8:9] nt
    v_add_u32 v76, s3, v76
    global_load_dwordx4 v[36:39], v76, s[8:9] nt
    v_add_u32 v76, s3, v76
    global_load_dwordx4 v[40:43], v76, s[8:9] nt
    s_load_dword s45, s[30:31], 0
    s_add_u32 s62, s30, 0x9f000
    s_addc_u32 s63, s31, 0
    s_lshl_b32 s39, s58, 8
    s_bitcmp1_b32 s33, 0
    s_cbranch_scc1 L_early_A
    v_lshl_add_u32 v16, v3, 3, s59
    v_lshl_add_u32 v17, v2, 4, s39
    v_lshl_add_u32 v76, v16, 13, v17
    s_lshl2_add_u32 s39, s35, s34
    s_lshl_b32 s39, s39, 9
    s_add_u32 s39, s39, 0x1000
    v_lshl_add_u32 v12, v1, 7, s39
    s_mov_b64 exec, 0xf
    global_load_dword v255, v12, s[62:63] sc1
    s_mov_b64 exec, -1
    global_load_dwordx4 v[44:47], v76, s[10:11] nt
    v_add_u32 v76, s3, v76
    global_load_dwordx4 v[48:51], v76, s[10:11] nt
    v_add_u32 v76, s3, v76
    global_load_dwordx4 v[52:55], v76, s[10:11] nt
    v_add_u32 v76, s3, v76
    global_load_dwordx4 v[56:59], v76, s[10:11] nt
    v_add_u32 v76, s3, v76
    s_branch L_f1
L_early_A:
    v_lshrrev_b32 v16, 1, v1
    v_add_u32 v16, s59, v16
    v_and_b32 v17, 1, v1
    v_lshl_add_u32 v17, v17, 7, s39
    v_lshl_add_u32 v16, v16, 13, v17
    s_mov_b32 exec_lo, 0xff00ff00
    s_mov_b32 exec_hi, 0xff00ff00
    global_load_dword v255, v16, s[10:11]
    s_mov_b64 exec, -1
L_f1:
    v_and_b32 v16, 1, v1
    v_lshlrev_b32 v16, 4, v16
    v_mov_b32 v17, 0xffff
    v_lshlrev_b32 v16, v16, v17
    v_lshrrev_b32 v17, 1, v15
    v_mov_b32 v4, 0x0402010c
    v_cmp_eq_u32 vcc, 0, v17
    s_nop 1
    v_cndmask_b32 v8, 0, v16, vcc
    v_cmp_eq_u32 vcc, 1, v17
    s_nop 1
    v_cndmask_b32 v9, 0, v16, vcc
    v_cmp_eq_u32 vcc, 2, v17
    s_nop 1
    v_cndmask_b32 v10, 0, v16, vcc
    v_cmp_eq_u32 vcc, 3, v17
    s_nop 1
    v_cndmask_b32 v11, 0, v16, vcc
    s_lshl_b32 s39, s34, 10
    v_add_u32 v5, s39, v5
    v_and_b32 v17, 3, v1
    v_lshl_add_u32 v7, v3, 2, v17
    v_lshrrev_b32 v16, 2, v2
    v_and_b32 v18, 8, v7
    v_add_u32 v18, v18, v7
    v_lshlrev_b32 v18, 4, v18
    v_lshl_add_u32 v6, v16, 10, v18
    v_add_u32 v6, 152064, v6
    v_add_u32 v19, 152064, v5
    s_and_b32 s39, s33, 1
    s_lshl1_add_u32 s39, s35, s39
    s_and_b32 s48, s36, 3
    s_lshl2_add_u32 s39, s39, s48
    s_lshl_b32 s39, s39, 8
    s_add_u32 s39, s39, 0x1000
    v_lshl_add_u32 v78, v7, 4, s39
    s_lshl_b32 s39, s58, 11
    s_add_u32 s39, s39, 0x1000
    v_lshrrev_b32 v12, 3, v2
    v_lshl_add_u32 v12, v12, 2, v3
    v_lshlrev_b32 v12, 8, v12
    v_lshl_add_u32 v12, v15, 4, v12
    v_add_u32 v26, s39, v12
    v_mov_b32 v95, 0x3f803f80
    s_mov_b32 s41, 0x07060501
    s_mov_b32 s42, 0x07060502
    s_mov_b32 s43, 0x07060503
    s_mov_b32 s44, 0x0c04000c
    s_lshl_b32 s39, s34, 4
    s_lshl_b64 s[48:49], 15, s39
    s_waitcnt lgkmcnt(0)
    s_mul_i32 s40, s45, 0x9e3779b1
    s_add_u32 s40, s40, 0x7f4a7c15
    s_bitcmp1_b32 s33, 0
    s_cbranch_scc0 L_xw
    s_waitcnt vmcnt(5)
    s_branch L_xw2
L_xw:
    s_mov_b64 exec, 0
    s_cmp_eq_u32 s34, 0
    s_cbranch_scc1 L_pf_n0
L_pf_n_ret:
    s_mov_b64 exec, -1
    s_waitcnt vmcnt(9)
L_xw2:
    v_dot2_f32_bf16 v92, v20, v95, 0
    v_dot2_f32_bf16 v93, v20, v20, 0
    v_dot2_f32_bf16 v92, v21, v95, v92
    v_dot2_f32_bf16 v93, v21, v21, v93
    v_dot2_f32_bf16 v92, v22, v95, v92
    v_dot2_f32_bf16 v93, v22, v22, v93
    v_dot2_f32_bf16 v92, v23, v95, v92
    v_dot2_f32_bf16 v93, v23, v23, v93
    v_lshlrev_b32 v88, 16, v24
    v_and_b32 v89, 0xffff0000, v24
    v_add_f32_dpp v92, v92, v92 row_ror:8 row_mask:0xf bank_mask:0xf
    v_add_f32_dpp v93, v93, v93 row_ror:8 row_mask:0xf bank_mask:0xf
    v_lshlrev_b32 v90, 16, v25
    v_add_f32_dpp v92, v92, v92 row_ror:4 row_mask:0xf bank_mask:0xf
    v_add_f32_dpp v93, v93, v93 row_ror:4 row_mask:0xf bank_mask:0xf
    v_and_b32 v91, 0xffff0000, v25
    v_add_f32_dpp v92, v92, v92 row_ror:2 row_mask:0xf bank_mask:0xf
    v_add_f32_dpp v93, v93, v93 row_ror:2 row_mask:0xf bank_mask:0xf
    s_nop 0
    v_add_f32_dpp v92, v92, v92 row_ror:1 row_mask:0xf bank_mask:0xf
    v_add_f32_dpp v93, v93, v93 row_ror:1 row_mask:0xf bank_mask:0xf
    v_mov_b32 v80, v92
    v_mov_b32 v81, v93
    s_nop 0
    v_permlane16_swap_b32 v92, v80
    v_permlane16_swap_b32 v93, v81
    v_add_f32 v92, v92, v80
    v_add_f32 v93, v93, v81
    v_mov_b32 v80, v92
    v_mov_b32 v81, v93
    s_nop 0
    v_permlane32_swap_b32 v92, v80
    v_permlane32_swap_b32 v93, v81
    v_add_f32 v92, v92, v80
    v_add_f32 v93, v93, v81
    v_mul_f32 v92, 0x3b000000, v92
    v_mul_f32 v93, 0x3b000000, v93
    v_fma_f32 v93, -v92, v92, v93
    v_max_f32 v93, 0, v93
    v_add_f32 v93, 0x3727c5ac, v93
    v_rsq_f32 v93, v93
    v_sub_f32 v88, v88, v92
    v_sub_f32 v89, v89, v92
    v_sub_f32 v90, v90, v92
    v_sub_f32 v91, v91, v92
    v_mul_f32 v93, 0x3e0293ee, v93
    v_mul_f32 v88, v88, v93
    v_mul_f32 v89, v89, v93
    v_mul_f32 v90, v90, v93
    v_mul_f32 v91, v91, v93
    v_cvt_pk_bf16_f32 v88, v88, v88
    v_cvt_pk_bf16_f32 v89, v89, v89
    v_cvt_pk_bf16_f32 v90, v90, v90
    v_cvt_pk_bf16_f32 v91, v91, v91
    v_and_b32 v100, v88, v8
    v_and_b32 v101, v88, v9
    v_and_b32 v102, v88, v10
    v_and_b32 v103, v88, v11
    v_and_b32 v104, v89, v8
    v_and_b32 v105, v89, v9
    v_and_b32 v106, v89, v10
    v_and_b32 v107, v89, v11
    v_and_b32 v108, v90, v8
    v_and_b32 v109, v90, v9
    v_and_b32 v110, v90, v10
    v_and_b32 v111, v90, v11
    v_and_b32 v112, v91, v8
    v_and_b32 v113, v91, v9
    v_and_b32 v114, v91, v10
    v_and_b32 v115, v91, v11
    v_mov_b32 v119, s40
    s_bitcmp1_b32 s33, 0
    s_cbranch_scc0 L_ww
    global_load_lds_dwordx4 v77, s[6:7] offset:0
    s_add_u32 m0, m0, 32
    s_nop 0
    global_load_lds_dwordx4 v77, s[6:7] offset:1024
    s_waitcnt vmcnt(3)
    s_branch L_ww2
L_ww:
    s_waitcnt vmcnt(5)
L_ww2:
    v_mfma_f32_16x16x32_bf16 v[96:99], v[100:103], v[28:31], 0
    v_mfma_f32_16x16x32_bf16 v[96:99], v[104:107], v[32:35], v[96:99]
    v_mfma_f32_16x16x32_bf16 v[96:99], v[108:111], v[36:39], v[96:99]
    v_mfma_f32_16x16x32_bf16 v[96:99], v[112:115], v[40:43], v[96:99]
    s_nop 7
    ds_write_b128 v19, v[96:99]
    s_waitcnt lgkmcnt(0)
    s_barrier
    ds_read_b128 v[120:123], v6
    ds_read_b128 v[124:127], v6 offset:640
    s_waitcnt lgkmcnt(0)
    v_add_f32 v120, v120, v124
    v_add_f32 v121, v121, v125
    v_add_f32 v122, v122, v126
    v_add_f32 v123, v123, v127
    v_add_f32_dpp v120, v120, v120 row_ror:4 row_mask:0xf bank_mask:0xf
    v_add_f32_dpp v121, v121, v121 row_ror:4 row_mask:0xf bank_mask:0xf
    v_add_f32_dpp v122, v122, v122 row_ror:4 row_mask:0xf bank_mask:0xf
    v_add_f32_dpp v123, v123, v123 row_ror:4 row_mask:0xf bank_mask:0xf
    v_add_f32_dpp v120, v120, v120 row_ror:8 row_mask:0xf bank_mask:0xf
    v_add_f32_dpp v121, v121, v121 row_ror:8 row_mask:0xf bank_mask:0xf
    v_add_f32_dpp v122, v122, v122 row_ror:8 row_mask:0xf bank_mask:0xf
    v_add_f32_dpp v123, v123, v123 row_ror:8 row_mask:0xf bank_mask:0xf
    v_perm_b32 v116, v120, v123, s41
    v_perm_b32 v117, v121, v123, s42
    v_perm_b32 v118, v122, v123, s43
    s_mov_b64 exec, s[48:49]
    global_store_dwordx4 v78, v[116:119], s[62:63]
    s_mov_b64 exec, -1
    s_bitcmp1_b32 s33, 0
    s_cbranch_scc0 L_roleN
    s_mov_b64 exec, s[48:49]
    global_store_dwordx4 v78, v[116:119], s[30:31] sc1
    s_mov_b64 exec, -1
    s_barrier
    s_add_u32 m0, m0, 32
    s_nop 0
    global_load_lds_dwordx4 v77, s[6:7] offset:2048
    s_add_u32 m0, m0, 32
    s_nop 0
    global_load_lds_dwordx4 v77, s[6:7] offset:3072
    s_add_u32 m0, m0, 4128
    v_add_u32 v77, 0x1000, v77
    global_load_lds_dwordx4 v77, s[6:7] offset:0
    s_add_u32 m0, m0, 32
    s_nop 0
    global_load_lds_dwordx4 v77, s[6:7] offset:1024
    s_add_u32 m0, m0, 32
    s_nop 0
    global_load_lds_dwordx4 v77, s[6:7] offset:2048
    s_add_u32 m0, m0, 32
    s_nop 0
    global_load_lds_dwordx4 v77, s[6:7] offset:3072
    s_add_u32 m0, m0, 4128
    v_add_u32 v77, 0x1000, v77
    global_load_lds_dwordx4 v77, s[6:7] offset:0
    s_add_u32 m0, m0, 32
    s_nop 0
    global_load_lds_dwordx4 v77, s[6:7] offset:1024
    s_lshl4_add_u32 s49, s32, s36
    s_lshl_b32 s39, s49, 7
    s_add_u32 s39, s39, 0x40000
    v_lshl_add_u32 v192, v2, 3, s39
    v_lshl_add_u32 v192, v3, 14, v192
    v_mov_b32 v149, s40
    s_lshl2_add_u32 s39, s49, s34
    s_lshl_b32 s39, s39, 7
    s_add_u32 s39, s39, 0x300000
    v_lshl_add_u32 v158, v7, 3, s39
    s_and_b32 s39, s36, 1
    s_lshl_b32 s39, s39, 12
    s_lshl_b32 s48, s34, 6
    s_add_u32 s39, s39, s48
    s_lshr_b32 s48, s49, 1
    s_add_u32 s39, s39, s48
    v_lshl_add_u32 v12, v3, 10, s39
    v_lshlrev_b32 v13, 4, v2
    v_lshl_add_u32 v13, v12, 8, v13
    v_add_u32 v152, 0x100000, v13
    v_mov_b32 v232, 0x3f803f80
    v_add_u32 v153, 0x110000, v13
    v_mov_b32 v233, 0x3f803f80
    v_add_u32 v154, 0x120000, v13
    v_mov_b32 v234, 0x3f803f80
    v_add_u32 v155, 0x130000, v13
    v_mov_b32 v235, 0x3f803f80
    s_mov_b32 s39, 0x9e3779b1
    s_mov_b32 s98, 0xaaaaaaaa
    s_mov_b32 s99, 0xaaaaaaaa
    s_mov_b32 s100, 0xcccccccc
    s_mov_b32 s101, 0xcccccccc
    v_lshl_add_u32 v160, v2, 2, 2
    v_mul_lo_u32 v160, v160, s39
    v_lshrrev_b32 v12, 15, v160
    v_xor_b32 v160, v160, v12
    v_or_b32 v160, 0x00010001, v160
    v_lshl_add_u32 v161, v2, 2, 3
    v_mul_lo_u32 v161, v161, s39
    v_lshrrev_b32 v12, 15, v161
    v_xor_b32 v161, v161, v12
    v_or_b32 v161, 0x00010001, v161
    v_lshl_add_u32 v162, v2, 2, 4
    v_mul_lo_u32 v162, v162, s39
    v_lshrrev_b32 v12, 15, v162
    v_xor_b32 v162, v162, v12
    v_or_b32 v162, 0x00010001, v162
    v_lshl_add_u32 v163, v2, 2, 5
    v_mul_lo_u32 v163, v163, s39
    v_lshrrev_b32 v12, 15, v163
    v_xor_b32 v163, v163, v12
    v_or_b32 v163, 0x00010001, v163
    s_mul_i32 s46, s32, 43
    s_add_u32 s48, s46, 43
    s_lshr_b32 s46, s46, 3
    s_lshr_b32 s48, s48, 3
    s_lshl2_add_u32 s49, s49, s34
    s_lshl_b32 s39, s49, 13
    v_lshl_add_u32 v206, v1, 7, s39
    s_and_b32 s53, s36, 7
    s_add_u32 s37, s53, s46
    s_and_b32 s49, s49, 31
    v_lshrrev_b32 v204, 2, v1
    v_lshl_add_u32 v204, s49, 4, v204
    v_mul_u32_u24 v204, 2752, v204
    s_lshl_b32 s39, s46, 6
    v_lshl_add_u32 v13, v17, 7, s39
    s_lshl_b32 s39, s48, 6
    s_sub_u32 s39, s39, 4
    v_min_u32 v13, s39, v13
    v_add_u32 v204, v204, v13
    s_mov_b32 s46, s48
    v_bfe_u32 v18, v1, 2, 3
    v_lshrrev_b32 v13, 5, v1
    v_lshl_add_u32 v18, v18, 1, v13
    v_lshl_add_u32 v18, v18, 3, v17
    s_lshl_b32 s39, s34, 8
    v_lshl_add_u32 v18, v18, 1, s39
    v_lshlrev_b32 v16, 4, v1
    s_cmp_lt_u32 s36, 8
    s_cbranch_scc1 L_noxw
    global_load_ushort v236, v18, s[4:5]
    global_load_ushort v237, v18, s[4:5] offset:8
    s_cmp_lt_u32 s36, 14
    s_cbranch_scc1 L_noxw
    global_load_dwordx4 v[240:243], v16, s[18:19]
L_noxw:
    s_mul_i32 s48, s34, 33792
    v_mul_u32_u24 v12, 1056, v2
    v_lshl_add_u32 v12, v3, 4, v12
    v_add_u32 v20, s48, v12
    v_add_u32 v22, 135168, v12
    v_lshrrev_b32 v12, 2, v1
    v_mul_u32_u24 v12, 1056, v12
    v_lshl_add_u32 v12, v17, 3, v12
    v_add_u32 v23, s39, v12
    v_add_u32 v24, 67584, v23
    s_and_b32 s39, s36, 1
    s_lshl_b32 s39, s39, 15
    s_add_u32 s39, s39, 0x21000
    v_add_u32 v26, s39, v5
    v_add_u32 v27, 0x2000, v26
    v_add_u32 v28, 0x4000, v26
    v_add_u32 v29, 0x6000, v26
    s_lshr_b32 s39, s34, 1
    s_mul_i32 s39, s39, 1056
    s_and_b32 s48, s34, 1
    s_lshl_b32 s48, s48, 9
    s_add_u32 s39, s39, s48
    s_add_u32 s39, s39, 135168
    v_lshl_add_u32 v25, v1, 3, s39
    v_add_u32 v144, 152064, v5
    v_lshlrev_b32 v12, 5, v1
    v_add_u32 v147, 156160, v12
    s_lshl_b32 s39, s34, 3
    v_add_u32 v145, s39, v147
    v_add_u32 v146, 152064, v16
    s_andn2_b32 s39, 1, s36
    s_mul_i32 s39, s39, 10240
    s_add_u32 s39, s39, s52
    v_add_u32 v77, s39, v16
    s_add_u32 s39, s52, 20480
    v_add_u32 v12, s39, v16
    s_branch L_page1
.p2align 12
L_page1:
    s_mov_b64 exec, 0
    s_cmp_eq_u32 s34, 0
    s_cbranch_scc1 L_pf_q0
    s_cmp_eq_u32 s34, 1
    s_cbranch_scc1 L_pf_q1
L_pf_q_ret:
    s_mov_b64 exec, -1
    s_waitcnt vmcnt(4)
    s_add_u32 m0, m0, 2080
    s_nop 0
    global_load_lds_dwordx4 v77, s[6:7] offset:0
    s_add_u32 m0, m0, 32
    s_nop 0
    global_load_lds_dwordx4 v77, s[6:7] offset:1024
    s_add_u32 m0, m0, 32
    s_nop 0
    global_load_lds_dwordx4 v77, s[6:7] offset:2048
    s_add_u32 m0, m0, 32
    s_nop 0
    global_load_lds_dwordx4 v77, s[6:7] offset:3072
    s_add_u32 m0, m0, 4128
    v_add_u32 v77, 0x1000, v77
    global_load_lds_dwordx4 v77, s[6:7] offset:0
    s_add_u32 m0, m0, 32
    s_nop 0
    global_load_lds_dwordx4 v77, s[6:7] offset:1024
    s_add_u32 m0, m0, 32
    s_nop 0
    global_load_lds_dwordx4 v77, s[6:7] offset:2048
    s_add_u32 m0, m0, 32
    s_nop 0
    global_load_lds_dwordx4 v77, s[6:7] offset:3072
    s_add_u32 m0, m0, 4128
    v_add_u32 v77, 0x1000, v77
    global_load_lds_dwordx4 v77, s[6:7] offset:0
    s_add_u32 m0, m0, 32
    s_nop 0
    global_load_lds_dwordx4 v77, s[6:7] offset:1024
    v_mov_b32 v77, v12
    s_add_u32 m0, m0, 2080
    s_nop 0
    global_load_lds_dwordx4 v77, s[6:7] offset:0
    s_add_u32 m0, m0, 32
    s_nop 0
    global_load_lds_dwordx4 v77, s[6:7] offset:1024
    s_add_u32 m0, m0, 32
    s_nop 0
    global_load_lds_dwordx4 v77, s[6:7] offset:2048
    s_add_u32 m0, m0, 32
    s_nop 0
    global_load_lds_dwordx4 v77, s[6:7] offset:3072
    s_add_u32 m0, m0, 4128
    v_add_u32 v77, 0x1000, v77
    global_load_lds_dwordx4 v77, s[6:7] offset:0
    s_add_u32 m0, m0, 32
    s_nop 0
    global_load_lds_dwordx4 v77, s[6:7] offset:1024
    s_add_u32 m0, m0, 32
    s_nop 0
    global_load_lds_dwordx4 v77, s[6:7] offset:2048
    s_add_u32 m0, m0, 32
    s_nop 0
    global_load_lds_dwordx4 v77, s[6:7] offset:3072
    s_add_u32 m0, m0, 4128
    v_add_u32 v77, 0x1000, v77
    global_load_lds_dwordx4 v77, s[6:7] offset:0
    s_waitcnt vmcnt(13)
    ds_read_b128 a[0:3], v20 offset:0
    ds_read_b128 a[4:7], v20 offset:64
    ds_read_b128 a[8:11], v20 offset:128
    ds_read_b128 a[12:15], v20 offset:192
    s_add_u32 m0, m0, 32
    s_nop 0
    global_load_lds_dwordx4 v77, s[6:7] offset:1024
    ds_read_b128 a[16:19], v20 offset:256
    ds_read_b128 a[20:23], v20 offset:320
    ds_read_b128 a[24:27], v20 offset:384
    ds_read_b128 a[28:31], v20 offset:448
    s_add_u32 m0, m0, 32
    s_nop 0
    global_load_lds_dwordx4 v77, s[6:7] offset:2048
    ds_read_b128 a[32:35], v20 offset:512
    ds_read_b128 a[36:39], v20 offset:576
    ds_read_b128 a[40:43], v20 offset:640
    ds_read_b128 a[44:47], v20 offset:704
    s_add_u32 m0, m0, 32
    s_nop 0
    global_load_lds_dwordx4 v77, s[6:7] offset:3072
    ds_read_b128 a[48:51], v20 offset:768
    ds_read_b128 a[52:55], v20 offset:832
    ds_read_b128 a[56:59], v20 offset:896
    ds_read_b128 a[60:63], v20 offset:960
    s_barrier
    global_load_dwordx3 v[32:34], v26, s[30:31] offset:-4096 sc1
    global_load_dwordx3 v[36:38], v26, s[30:31] offset:0 sc1
    global_load_dwordx3 v[40:42], v27, s[30:31] offset:-4096 sc1
    global_load_dwordx3 v[44:46], v27, s[30:31] offset:0 sc1
    global_load_dwordx3 v[48:50], v28, s[30:31] offset:-4096 sc1
    global_load_dwordx3 v[52:54], v28, s[30:31] offset:0 sc1
    global_load_dwordx3 v[56:58], v29, s[30:31] offset:-4096 sc1
    global_load_dwordx3 v[60:62], v29, s[30:31] offset:0 sc1
    ds_read_b64_tr_b16 a[128:129], v23 offset:0
    ds_read_b64_tr_b16 a[132:133], v23 offset:32
    ds_read_b64_tr_b16 a[136:137], v23 offset:64
    ds_read_b64_tr_b16 a[140:141], v23 offset:96
    ds_read_b64_tr_b16 a[144:145], v23 offset:128
    ds_read_b64_tr_b16 a[148:149], v23 offset:160
    ds_read_b64_tr_b16 a[152:153], v23 offset:192
    ds_read_b64_tr_b16 a[156:157], v23 offset:224
    ds_read_b64_tr_b16 a[160:161], v23 offset:33792
    ds_read_b64_tr_b16 a[164:165], v23 offset:33824
    ds_read_b64_tr_b16 a[168:169], v23 offset:33856
    ds_read_b64_tr_b16 a[172:173], v23 offset:33888
    ds_read_b64_tr_b16 a[176:177], v23 offset:33920
    ds_read_b64_tr_b16 a[180:181], v23 offset:33952
    ds_read_b64_tr_b16 a[184:185], v23 offset:33984
    ds_read_b64_tr_b16 a[188:189], v23 offset:34016
    ds_read_b64_tr_b16 a[192:193], v24 offset:0
    ds_read_b64_tr_b16 a[196:197], v24 offset:32
    ds_read_b64_tr_b16 a[200:201], v24 offset:64
    ds_read_b64_tr_b16 a[204:205], v24 offset:96
    ds_read_b64_tr_b16 a[208:209], v24 offset:128
    ds_read_b64_tr_b16 a[212:213], v24 offset:160
    ds_read_b64_tr_b16 a[216:217], v24 offset:192
    ds_read_b64_tr_b16 a[220:221], v24 offset:224
    ds_read_b64_tr_b16 a[224:225], v24 offset:33792
    ds_read_b64_tr_b16 a[228:229], v24 offset:33824
    ds_read_b64_tr_b16 a[232:233], v24 offset:33856
    ds_read_b64_tr_b16 a[236:237], v24 offset:33888
    ds_read_b64_tr_b16 a[240:241], v24 offset:33920
    ds_read_b64_tr_b16 a[244:245], v24 offset:33952
    ds_read_b64_tr_b16 a[248:249], v24 offset:33984
    ds_read_b64_tr_b16 a[252:253], v24 offset:34016
    s_waitcnt vmcnt(8)
    ds_read_b128 a[64:67], v20 offset:16896
    ds_read_b128 a[68:71], v20 offset:16960
    ds_read_b128 a[72:75], v20 offset:17024
    ds_read_b128 a[76:79], v20 offset:17088
    ds_read_b128 a[80:83], v20 offset:17152
    ds_read_b128 a[84:87], v20 offset:17216
    ds_read_b128 a[88:91], v20 offset:17280
    ds_read_b128 a[92:95], v20 offset:17344
    ds_read_b128 a[96:99], v20 offset:17408
    ds_read_b128 a[100:103], v20 offset:17472
    ds_read_b128 a[104:107], v20 offset:17536
    ds_read_b128 a[108:111], v20 offset:17600
    ds_read_b128 a[112:115], v20 offset:17664
    ds_read_b128 a[116:119], v20 offset:17728
    ds_read_b128 a[120:123], v20 offset:17792
    ds_read_b128 a[124:127], v20 offset:17856
    s_barrier
    ds_read_b64_tr_b16 a[130:131], v23 offset:16896
    ds_read_b64_tr_b16 a[134:135], v23 offset:16928
    ds_read_b64_tr_b16 a[138:139], v23 offset:16960
    ds_read_b64_tr_b16 a[142:143], v23 offset:16992
    ds_read_b64_tr_b16 a[146:147], v23 offset:17024
    ds_read_b64_tr_b16 a[150:151], v23 offset:17056
    ds_read_b64_tr_b16 a[154:155], v23 offset:17088
    ds_read_b64_tr_b16 a[158:159], v23 offset:17120
    ds_read_b64_tr_b16 a[162:163], v23 offset:50688
    ds_read_b64_tr_b16 a[166:167], v23 offset:50720
    ds_read_b64_tr_b16 a[170:171], v23 offset:50752
    ds_read_b64_tr_b16 a[174:175], v23 offset:50784
    ds_read_b64_tr_b16 a[178:179], v23 offset:50816
    ds_read_b64_tr_b16 a[182:183], v23 offset:50848
    ds_read_b64_tr_b16 a[186:187], v23 offset:50880
    ds_read_b64_tr_b16 a[190:191], v23 offset:50912
    s_mov_b32 s47, 0x1fffff
    s_branch L_ql_wait
L_ql_retry:
    s_sub_u32 s47, s47, 1
    s_cbranch_scc1 L_ql_done
    s_mov_b64 exec, s[8:9]
    s_cbranch_execz L_ql_s0
    global_load_dwordx3 v[32:34], v26, s[30:31] offset:-4096 sc1
L_ql_s0:
    s_mov_b64 exec, s[10:11]
    s_cbranch_execz L_ql_s1
    global_load_dwordx3 v[36:38], v26, s[30:31] offset:0 sc1
L_ql_s1:
    s_mov_b64 exec, s[12:13]
    s_cbranch_execz L_ql_s2
    global_load_dwordx3 v[40:42], v27, s[30:31] offset:-4096 sc1
L_ql_s2:
    s_mov_b64 exec, s[16:17]
    s_cbranch_execz L_ql_s3
    global_load_dwordx3 v[44:46], v27, s[30:31] offset:0 sc1
L_ql_s3:
    s_mov_b64 exec, s[28:29]
    s_cbranch_execz L_ql_s4
    global_load_dwordx3 v[48:50], v28, s[30:31] offset:-4096 sc1
L_ql_s4:
    s_mov_b64 exec, s[54:55]
    s_cbranch_execz L_ql_s5
    global_load_dwordx3 v[52:54], v28, s[30:31] offset:0 sc1
L_ql_s5:
    s_mov_b64 exec, s[56:57]
    s_cbranch_execz L_ql_s6
    global_load_dwordx3 v[56:58], v29, s[30:31] offset:-4096 sc1
L_ql_s6:
    s_mov_b64 exec, s[58:59]
    s_cbranch_execz L_ql_s7
    global_load_dwordx3 v[60:62], v29, s[30:31] offset:0 sc1
L_ql_s7:
    s_mov_b64 exec, -1
L_ql_wait:
    s_waitcnt vmcnt(0)
    v_cmp_ne_u32 s[8:9], s40, v34
    v_cmp_ne_u32 s[10:11], s40, v38
    v_cmp_ne_u32 s[12:13], s40, v42
    v_cmp_ne_u32 s[16:17], s40, v46
    v_cmp_ne_u32 s[28:29], s40, v50
    v_cmp_ne_u32 s[54:55], s40, v54
    v_cmp_ne_u32 s[56:57], s40, v58
    v_cmp_ne_u32 s[58:59], s40, v62
    s_or_b64 vcc, s[8:9], s[10:11]
    s_or_b64 vcc, vcc, s[12:13]
    s_or_b64 vcc, vcc, s[16:17]
    s_or_b64 vcc, vcc, s[28:29]
    s_or_b64 vcc, vcc, s[54:55]
    s_or_b64 vcc, vcc, s[56:57]
    s_or_b64 vcc, vcc, s[58:59]
    s_cbranch_scc1 L_ql_retry
L_ql_done:
    ds_write_b64 v25, v[32:33] offset:0
    ds_write_b64 v25, v[36:37] offset:2112
    ds_write_b64 v25, v[40:41] offset:4224
    ds_write_b64 v25, v[44:45] offset:6336
    ds_write_b64 v25, v[48:49] offset:8448
    ds_write_b64 v25, v[52:53] offset:10560
    ds_write_b64 v25, v[56:57] offset:12672
    ds_write_b64 v25, v[60:61] offset:14784
    s_waitcnt lgkmcnt(0)
    s_barrier
    ds_read_b128 v[80:83], v22 offset:0
    ds_read_b128 v[84:87], v22 offset:64
    ds_read_b128 v[88:91], v22 offset:128
    global_load_dword v255, v206, s[14:15]
    s_waitcnt lgkmcnt(2)
    v_mfma_f32_16x16x32_bf16 v[32:35], a[0:3], v[80:83], 0
    ds_read_b128 v[92:95], v22 offset:192
    v_mfma_f32_16x16x32_bf16 v[36:39], a[64:67], v[80:83], 0
    ds_read_b128 v[96:99], v22 offset:256
    s_waitcnt lgkmcnt(3)
    v_mfma_f32_16x16x32_bf16 v[32:35], a[4:7], v[84:87], v[32:35]
    ds_read_b128 v[100:103], v22 offset:320
    v_mfma_f32_16x16x32_bf16 v[36:39], a[68:71], v[84:87], v[36:39]
    ds_read_b128 v[104:107], v22 offset:384
    s_waitcnt lgkmcnt(4)
    v_mfma_f32_16x16x32_bf16 v[32:35], a[8:11], v[88:91], v[32:35]
    ds_read_b128 v[108:111], v22 offset:448
    v_mfma_f32_16x16x32_bf16 v[36:39], a[72:75], v[88:91], v[36:39]
    ds_read_b128 v[112:115], v22 offset:512
    s_waitcnt lgkmcnt(5)
    v_mfma_f32_16x16x32_bf16 v[32:35], a[12:15], v[92:95], v[32:35]
    ds_read_b128 v[116:119], v22 offset:576
    v_mfma_f32_16x16x32_bf16 v[36:39], a[76:79], v[92:95], v[36:39]
    ds_read_b128 v[120:123], v22 offset:640
    s_waitcnt lgkmcnt(6)
    v_mfma_f32_16x16x32_bf16 v[32:35], a[16:19], v[96:99], v[32:35]
    ds_read_b128 v[124:127], v22 offset:704
    v_mfma_f32_16x16x32_bf16 v[36:39], a[80:83], v[96:99], v[36:39]
    ds_read_b128 v[128:131], v22 offset:768
    s_waitcnt lgkmcnt(7)
    v_mfma_f32_16x16x32_bf16 v[32:35], a[20:23], v[100:103], v[32:35]
    ds_read_b128 v[132:135], v22 offset:832
    v_mfma_f32_16x16x32_bf16 v[36:39], a[84:87], v[100:103], v[36:39]
    ds_read_b128 v[136:139], v22 offset:896
    s_waitcnt lgkmcnt(8)
    v_mfma_f32_16x16x32_bf16 v[32:35], a[24:27], v[104:107], v[32:35]
    ds_read_b128 v[140:143], v22 offset:960
    v_mfma_f32_16x16x32_bf16 v[36:39], a[88:91], v[104:107], v[36:39]
    ds_read_b64_tr_b16 a[194:195], v24 offset:16896
    s_waitcnt lgkmcnt(9)
    v_mfma_f32_16x16x32_bf16 v[32:35], a[28:31], v[108:111], v[32:35]
    ds_read_b64_tr_b16 a[198:199], v24 offset:16928
    v_mfma_f32_16x16x32_bf16 v[36:39], a[92:95], v[108:111], v[36:39]
    ds_read_b64_tr_b16 a[202:203], v24 offset:16960
    s_waitcnt lgkmcnt(10)
    v_mfma_f32_16x16x32_bf16 v[32:35], a[32:35], v[112:115], v[32:35]
    ds_read_b64_tr_b16 a[206:207], v24 offset:16992
    v_mfma_f32_16x16x32_bf16 v[36:39], a[96:99], v[112:115], v[36:39]
    ds_read_b64_tr_b16 a[210:211], v24 offset:17024
    s_waitcnt lgkmcnt(11)
    v_mfma_f32_16x16x32_bf16 v[32:35], a[36:39], v[116:119], v[32:35]
    ds_read_b64_tr_b16 a[214:215], v24 offset:17056
    v_mfma_f32_16x16x32_bf16 v[36:39], a[100:103], v[116:119], v[36:39]
    ds_read_b64_tr_b16 a[218:219], v24 offset:17088
    s_waitcnt lgkmcnt(12)
    v_mfma_f32_16x16x32_bf16 v[32:35], a[40:43], v[120:123], v[32:35]
    ds_read_b64_tr_b16 a[222:223], v24 offset:17120
    v_mfma_f32_16x16x32_bf16 v[36:39], a[104:107], v[120:123], v[36:39]
    ds_read_b64_tr_b16 a[226:227], v24 offset:50688
    s_waitcnt lgkmcnt(13)
    v_mfma_f32_16x16x32_bf16 v[32:35], a[44:47], v[124:127], v[32:35]
    ds_read_b64_tr_b16 a[230:231], v24 offset:50720
    v_mfma_f32_16x16x32_bf16 v[36:39], a[108:111], v[124:127], v[36:39]
    ds_read_b64_tr_b16 a[234:235], v24 offset:50752
    s_waitcnt lgkmcnt(14)
    v_mfma_f32_16x16x32_bf16 v[32:35], a[48:51], v[128:131], v[32:35]
    ds_read_b64_tr_b16 a[238:239], v24 offset:50784
    v_mfma_f32_16x16x32_bf16 v[36:39], a[112:115], v[128:131], v[36:39]
    ds_read_b64_tr_b16 a[242:243], v24 offset:50816
    s_waitcnt lgkmcnt(14)
    v_mfma_f32_16x16x32_bf16 v[32:35], a[52:55], v[132:135], v[32:35]
    ds_read_b64_tr_b16 a[246:247], v24 offset:50848
    v_mfma_f32_16x16x32_bf16 v[36:39], a[116:119], v[132:135], v[36:39]
    ds_read_b64_tr_b16 a[250:251], v24 offset:50880
    v_mfma_f32_16x16x32_bf16 v[32:35], a[56:59], v[136:139], v[32:35]
    ds_read_b64_tr_b16 a[254:255], v24 offset:50912
    v_mfma_f32_16x16x32_bf16 v[36:39], a[120:123], v[136:139], v[36:39]
    s_waitcnt lgkmcnt(14)
    v_mfma_f32_16x16x32_bf16 v[32:35], a[60:63], v[140:143], v[32:35]
    v_mfma_f32_16x16x32_bf16 v[36:39], a[124:127], v[140:143], v[36:39]
    s_nop 6
    v_max3_f32 v40, v32, v33, v34
    v_max3_f32 v40, v40, v35, v36
    v_max3_f32 v41, v37, v38, v39
    v_max_f32 v40, v40, v41
    v_ceil_f32 v40, v40
    v_sub_f32 v32, v32, v40
    v_mul_f32 v42, 0x43000000, v40
    v_sub_f32 v33, v33, v40
    v_mov_b32 v43, v42
    v_sub_f32 v34, v34, v40
    v_mov_b32 v41, v42
    v_sub_f32 v35, v35, v40
    v_sub_f32 v36, v36, v40
    v_sub_f32 v37, v37, v40
    v_sub_f32 v38, v38, v40
    v_sub_f32 v39, v39, v40
    v_exp_f32 v32, v32
    v_exp_f32 v33, v33
    v_permlane16_swap_b32 v43, v41
    v_exp_f32 v34, v34
    v_max_f32 v43, v43, v41
    v_exp_f32 v35, v35
    v_mov_b32 v41, v43
    v_exp_f32 v36, v36
    v_exp_f32 v37, v37
    v_permlane32_swap_b32 v43, v41
    v_exp_f32 v38, v38
    v_max_f32 v43, v43, v41
    v_exp_f32 v39, v39
    ds_write_b64 v145, v[42:43]
    v_cvt_pk_bf16_f32 v32, v32, v33
    v_cvt_pk_bf16_f32 v33, v34, v35
    v_cvt_pk_bf16_f32 v34, v36, v37
    v_cvt_pk_bf16_f32 v35, v38, v39
    ds_write_b128 v144, v[32:35]
    s_waitcnt lgkmcnt(0)
    s_barrier
    ds_read_b128 v[64:67], v147
    ds_read_b128 v[68:71], v147 offset:16
    ds_read_b128 v[48:51], v146 offset:0
    ds_read_b128 v[52:55], v146 offset:1024
    ds_read_b128 v[56:59], v146 offset:2048
    ds_read_b128 v[60:63], v146 offset:3072
    s_cmp_lg_u32 s34, 0
    s_waitcnt lgkmcnt(4)
    v_max3_f32 v148, v65, v67, v69
    v_max_f32 v148, v148, v71
    s_cbranch_scc1 L_h1
    global_store_dwordx2 v192, v[148:149], s[30:31] sc1
L_h1:
    v_sub_f32 v64, v148, v64
    v_cvt_u32_f32 v64, v64
    v_cvt_pk_u16_u32 v64, v64, v64
    s_waitcnt lgkmcnt(3)
    v_pk_sub_u16 v48, v48, v64 clamp
    v_pk_sub_u16 v49, v49, v64 clamp
    v_pk_sub_u16 v50, v50, v64 clamp
    v_pk_sub_u16 v51, v51, v64 clamp
    v_sub_f32 v66, v148, v66
    v_cvt_u32_f32 v66, v66
    v_mfma_f32_16x16x32_bf16 v[80:83], v[48:51], a[128:131], 0
    v_cvt_pk_u16_u32 v66, v66, v66
    s_waitcnt lgkmcnt(0)
    v_pk_sub_u16 v52, v52, v66 clamp
    v_mfma_f32_16x16x32_bf16 v[84:87], v[48:51], a[132:135], 0
    v_pk_sub_u16 v53, v53, v66 clamp
    v_pk_sub_u16 v54, v54, v66 clamp
    v_pk_sub_u16 v55, v55, v66 clamp
    v_mfma_f32_16x16x32_bf16 v[88:91], v[48:51], a[136:139], 0
    v_sub_f32 v68, v148, v68
    v_cvt_u32_f32 v68, v68
    v_cvt_pk_u16_u32 v68, v68, v68
    v_mfma_f32_16x16x32_bf16 v[92:95], v[48:51], a[140:143], 0
    v_pk_sub_u16 v56, v56, v68 clamp
    v_pk_sub_u16 v57, v57, v68 clamp
    v_pk_sub_u16 v58, v58, v68 clamp
    v_mfma_f32_16x16x32_bf16 v[96:99], v[48:51], a[144:147], 0
    v_pk_sub_u16 v59, v59, v68 clamp
    v_sub_f32 v70, v148, v70
    v_cvt_u32_f32 v70, v70
    v_mfma_f32_16x16x32_bf16 v[100:103], v[48:51], a[148:151], 0
    v_cvt_pk_u16_u32 v70, v70, v70
    v_pk_sub_u16 v60, v60, v70 clamp
    v_mfma_f32_16x16x32_bf16 v[104:107], v[48:51], a[152:155], 0
    v_pk_sub_u16 v61, v61, v70 clamp
    v_pk_sub_u16 v62, v62, v70 clamp
    v_mfma_f32_16x16x32_bf16 v[108:111], v[48:51], a[156:159], 0
    v_pk_sub_u16 v63, v63, v70 clamp
    v_mfma_f32_16x16x32_bf16 v[80:83], v[52:55], a[160:163], v[80:83]
    v_mfma_f32_16x16x32_bf16 v[80:83], v[56:59], a[192:195], v[80:83]
    v_mfma_f32_16x16x32_bf16 v[80:83], v[60:63], a[224:227], v[80:83]
    v_mfma_f32_16x16x32_bf16 v[84:87], v[52:55], a[164:167], v[84:87]
    v_mfma_f32_16x16x32_bf16 v[84:87], v[56:59], a[196:199], v[84:87]
    v_mfma_f32_16x16x32_bf16 v[84:87], v[60:63], a[228:231], v[84:87]
    s_nop 1
    v_mfma_f32_16x16x32_bf16 v[88:91], v[52:55], a[168:171], v[88:91]
    s_nop 1
    v_mfma_f32_16x16x32_bf16 v[88:91], v[56:59], a[200:203], v[88:91]
    s_nop 1
    v_mfma_f32_16x16x32_bf16 v[88:91], v[60:63], a[232:235], v[88:91]
    v_cvt_pk_bf16_f32 v208, v80, v84
    v_cvt_pk_bf16_f32 v212, v81, v85
    v_mfma_f32_16x16x32_bf16 v[92:95], v[52:55], a[172:175], v[92:95]
    v_cvt_pk_bf16_f32 v216, v82, v86
    v_cvt_pk_bf16_f32 v220, v83, v87
    v_mfma_f32_16x16x32_bf16 v[92:95], v[56:59], a[204:207], v[92:95]
    v_dot2_u32_u16 v224, v208, v160, 0
    v_dot2_u32_u16 v225, v212, v160, 0
    v_mfma_f32_16x16x32_bf16 v[92:95], v[60:63], a[236:239], v[92:95]
    v_dot2_u32_u16 v226, v216, v160, 0
    v_dot2_u32_u16 v227, v220, v160, 0
    v_mfma_f32_16x16x32_bf16 v[96:99], v[52:55], a[176:179], v[96:99]
    v_xor_b32 v208, s40, v208
    v_xor_b32 v212, s40, v212
    v_mfma_f32_16x16x32_bf16 v[96:99], v[56:59], a[208:211], v[96:99]
    v_xor_b32 v216, s40, v216
    v_xor_b32 v220, s40, v220
    v_mfma_f32_16x16x32_bf16 v[96:99], v[60:63], a[240:243], v[96:99]
    v_cvt_pk_bf16_f32 v209, v88, v92
    v_cvt_pk_bf16_f32 v213, v89, v93
    v_mfma_f32_16x16x32_bf16 v[100:103], v[52:55], a[180:183], v[100:103]
    v_cvt_pk_bf16_f32 v217, v90, v94
    v_cvt_pk_bf16_f32 v221, v91, v95
    v_mfma_f32_16x16x32_bf16 v[100:103], v[56:59], a[212:215], v[100:103]
    v_dot2_u32_u16 v224, v209, v161, v224
    v_dot2_u32_u16 v225, v213, v161, v225
    v_mfma_f32_16x16x32_bf16 v[100:103], v[60:63], a[244:247], v[100:103]
    v_dot2_u32_u16 v226, v217, v161, v226
    v_dot2_u32_u16 v227, v221, v161, v227
    v_mfma_f32_16x16x32_bf16 v[104:107], v[52:55], a[184:187], v[104:107]
    s_nop 1
    v_mfma_f32_16x16x32_bf16 v[104:107], v[56:59], a[216:219], v[104:107]
    s_nop 1
    v_mfma_f32_16x16x32_bf16 v[104:107], v[60:63], a[248:251], v[104:107]
    v_cvt_pk_bf16_f32 v210, v96, v100
    v_cvt_pk_bf16_f32 v214, v97, v101
    v_mfma_f32_16x16x32_bf16 v[108:111], v[52:55], a[188:191], v[108:111]
    v_cvt_pk_bf16_f32 v218, v98, v102
    v_cvt_pk_bf16_f32 v222, v99, v103
    v_mfma_f32_16x16x32_bf16 v[108:111], v[56:59], a[220:223], v[108:111]
    v_dot2_u32_u16 v224, v210, v162, v224
    v_dot2_u32_u16 v225, v214, v162, v225
    v_mfma_f32_16x16x32_bf16 v[108:111], v[60:63], a[252:255], v[108:111]
    v_dot2_u32_u16 v226, v218, v162, v226
    v_dot2_u32_u16 v227, v222, v162, v227
    s_nop 5
    v_cvt_pk_bf16_f32 v211, v104, v108
    global_store_dwordx4 v152, v[208:211], s[30:31] sc1
    v_mfma_f32_16x16x32_bf16 v[72:75], v[48:51], v[232:235], 0
    v_cvt_pk_bf16_f32 v215, v105, v109
    v_cvt_pk_bf16_f32 v219, v106, v110
    v_mfma_f32_16x16x32_bf16 v[72:75], v[52:55], v[232:235], v[72:75]
    v_cvt_pk_bf16_f32 v223, v107, v111
    global_store_dwordx4 v153, v[212:215], s[30:31] sc1
    v_mfma_f32_16x16x32_bf16 v[72:75], v[56:59], v[232:235], v[72:75]
    v_dot2_u32_u16 v224, v211, v163, v224
    v_dot2_u32_u16 v225, v215, v163, v225
    v_mfma_f32_16x16x32_bf16 v[72:75], v[60:63], v[232:235], v[72:75]
    v_dot2_u32_u16 v226, v219, v163, v226
    v_dot2_u32_u16 v227, v223, v163, v227
    global_store_dwordx4 v154, v[216:219], s[30:31] sc1
    v_cndmask_b32 v229, v225, v224, s[98:99]
    s_nop 0
    v_cndmask_b32 v231, v227, v226, s[98:99]
    v_cndmask_b32 v228, v224, v225, s[98:99]
    v_cndmask_b32 v230, v226, v227, s[98:99]
    s_nop 0
    v_add_u32_dpp v228, v229, v228 quad_perm:[1,0,3,2] row_mask:0xf bank_mask:0xf
    v_add_u32_dpp v230, v231, v230 quad_perm:[1,0,3,2] row_mask:0xf bank_mask:0xf
    global_store_dwordx4 v155, v[220:223], s[30:31] sc1
    v_cndmask_b32 v229, v230, v228, s[100:101]
    v_cndmask_b32 v228, v228, v230, s[100:101]
    v_cndmask_b32 v72, v72, v73, s[98:99]
    s_nop 0
    v_add_u32_dpp v228, v229, v228 quad_perm:[2,3,0,1] row_mask:0xf bank_mask:0xf
    v_cndmask_b32 v74, v74, v75, s[98:99]
    v_cndmask_b32 v165, v72, v74, s[100:101]
    v_add_u32_dpp v228, v228, v228 row_ror:4 row_mask:0xf bank_mask:0xf
    s_nop 1
    v_add_u32_dpp v228, v228, v228 row_ror:8 row_mask:0xf bank_mask:0xf
    s_mov_b32 exec_lo, 0xf000f
    s_mov_b32 exec_hi, 0xf000f
    v_add3_u32 v164, v228, s40, v165
    global_store_dwordx2 v158, v[164:165], s[30:31] sc1
    s_mov_b64 exec, -1
    s_barrier
    s_cmp_ge_u32 s36, 8
    s_cbranch_scc0 L_roleO
    global_load_dword v255, v204, s[22:23]
    s_cmp_ge_u32 s53, 6
    s_cbranch_scc1 L_f_common
    s_cmp_ge_u32 s37, s46
    s_cbranch_scc1 L_idle
    s_lshl2_add_u32 s49, s37, s34
    s_lshl_b32 s39, s49, 9
    s_add_u32 s39, s39, 0x80000
    v_add_u32 v26, s39, v16
    s_not_b32 s39, s40
    v_mov_b32 v44, s39
    v_mov_b32 v45, s39
    v_mov_b32 v46, s39
    v_mov_b32 v47, s39
    s_mov_b32 exec_lo, 0xffffffff
    s_mov_b32 exec_hi, 0x0
    global_store_dwordx4 v26, v[44:47], s[30:31] sc1
    s_mov_b64 exec, -1
    s_lshl_b32 s39, s34, 7
    v_lshrrev_b32 v12, 2, v1
    v_add_u32 v12, s39, v12
    v_mul_u32_u24 v12, 2752, v12
    s_lshl_b32 s39, s37, 6
    v_xor_b32 v13, v17, v3
    v_lshl_add_u32 v13, v13, 4, s39
    v_add_u32 v12, v12, v13
    v_mov_b32 v13, v12
    s_mov_b32 s48, 44032
    s_lshl_b32 m0, s34, 13
    s_nop 0
    global_load_lds_dwordx4 v12, s[20:21]
    s_add_u32 m0, m0, 1024
    v_add_u32 v12, s48, v12
    global_load_lds_dwordx4 v12, s[20:21]
    s_add_u32 m0, m0, 1024
    v_add_u32 v12, s48, v12
    global_load_lds_dwordx4 v12, s[20:21]
    s_add_u32 m0, m0, 1024
    v_add_u32 v12, s48, v12
    global_load_lds_dwordx4 v12, s[20:21]
    s_add_u32 m0, m0, 1024
    v_add_u32 v12, s48, v12
    global_load_lds_dwordx4 v12, s[20:21]
    s_add_u32 m0, m0, 1024
    v_add_u32 v12, s48, v12
    global_load_lds_dwordx4 v12, s[20:21]
    s_add_u32 m0, m0, 1024
    v_add_u32 v12, s48, v12
    global_load_lds_dwordx4 v12, s[20:21]
    s_add_u32 m0, m0, 1024
    v_add_u32 v12, s48, v12
    global_load_lds_dwordx4 v12, s[20:21]
    s_add_u32 m0, m0, 25664
    s_nop 0
    global_load_lds_dwordx4 v13, s[22:23]
    s_add_u32 m0, m0, 1024
    v_add_u32 v13, s48, v13
    global_load_lds_dwordx4 v13, s[22:23]
    s_add_u32 m0, m0, 1024
    v_add_u32 v13, s48, v13
    global_load_lds_dwordx4 v13, s[22:23]
    s_add_u32 m0, m0, 1024
    v_add_u32 v13, s48, v13
    global_load_lds_dwordx4 v13, s[22:23]
    s_add_u32 m0, m0, 1024
    v_add_u32 v13, s48, v13
    global_load_lds_dwordx4 v13, s[22:23]
    s_add_u32 m0, m0, 1024
    v_add_u32 v13, s48, v13
    global_load_lds_dwordx4 v13, s[22:23]
    s_add_u32 m0, m0, 1024
    v_add_u32 v13, s48, v13
    global_load_lds_dwordx4 v13, s[22:23]
    s_add_u32 m0, m0, 1024
    v_add_u32 v13, s48, v13
    global_load_lds_dwordx4 v13, s[22:23]
    s_lshl_b32 s39, s49, 13
    v_add_u32 v12, s39, v16
    s_mul_i32 s39, s34, 8576
    s_add_u32 m0, s39, 73728
    s_nop 0
    global_load_lds_dwordx4 v12, s[24:25]
    s_add_u32 m0, m0, 1056
    v_add_u32 v12, 0x400, v12
    global_load_lds_dwordx4 v12, s[24:25]
    s_add_u32 m0, m0, 1056
    v_add_u32 v12, 0x400, v12
    global_load_lds_dwordx4 v12, s[24:25]
    s_add_u32 m0, m0, 1056
    v_add_u32 v12, 0x400, v12
    global_load_lds_dwordx4 v12, s[24:25]
    s_add_u32 m0, m0, 1056
    v_add_u32 v12, 0x400, v12
    global_load_lds_dwordx4 v12, s[24:25]
    s_add_u32 m0, m0, 1056
    v_add_u32 v12, 0x400, v12
    global_load_lds_dwordx4 v12, s[24:25]
    s_add_u32 m0, m0, 1056
    v_add_u32 v12, 0x400, v12
    global_load_lds_dwordx4 v12, s[24:25]
    s_add_u32 m0, m0, 1056
    v_add_u32 v12, 0x400, v12
    global_load_lds_dwordx4 v12, s[24:25]
    s_branch L_page2
.p2align 12
L_page2:
L_pf_q0:
    s_cbranch_execz L_pf_q_ret
    v_lshrrev_b32 v18, 2, v2
    v_lshrrev_b32 v12, 1, v3
    v_lshl_add_u32 v12, v12, 2, v18
    v_and_b32 v13, 1, v3
    v_lshl_add_u32 v12, v12, 1, v13
    v_lshlrev_b32 v12, 7, v12
    v_xor_b32 v13, s34, v18
    v_lshl_add_u32 v12, v13, 4, v12
    v_lshrrev_b32 v13, 1, v17
    v_mul_u32_u24 v13, 32832, v13
    v_add_u32 v12, v12, v13
    v_and_b32 v13, 1, v1
    v_lshl_add_u32 v24, v13, 3, v12
    s_lshl_b32 s39, s34, 4
    s_add_u32 s39, s39, 136192
    v_lshl_add_u32 v25, v2, 1, s39
    v_lshlrev_b32 v144, 4, v3
    v_add_u32 v144, 136192, v144
    v_mul_u32_u24 v12, 8576, v3
    v_mul_u32_u24 v13, 1056, v18
    v_add_u32 v12, v12, v13
    v_lshl_add_u32 v12, v17, 3, v12
    s_lshl_b32 s39, s34, 8
    s_add_u32 s39, s39, 73728
    v_add_u32 v19, s39, v12
    v_mov_b32 v151, s40
    v_mov_b32 v48, 0
    v_mov_b32 v49, 0
    v_mov_b32 v50, 0
    v_mov_b32 v51, 0
    v_mov_b32 v52, 0
    v_mov_b32 v53, 0
    v_mov_b32 v54, 0
    v_mov_b32 v55, 0
    s_lshl_b32 s39, s32, 5
    s_add_u32 s39, s39, s53
    s_lshl2_add_u32 s39, s39, 0xd9000
    v_lshl_add_u32 v28, v1, 2, s39
L_f_common:
    v_and_b32 v12, 31, v1
    v_lshrrev_b32 v13, 5, v1
    v_lshrrev_b32 v18, 2, v12
    v_lshl_add_u32 v18, v18, 1, v13
    v_lshl_add_u32 v18, v18, 2, v17
    s_lshl_b32 s39, s34, 8
    s_add_u32 s39, s39, 135168
    v_lshl_add_u32 v22, v18, 2, s39
    v_and_b32 v18, 1, v1
    v_lshl_add_u32 v18, v3, 1, v18
    v_lshlrev_b32 v23, 4, v18
    v_add_u32 v23, 135168, v23
    v_and_b32 v145, 1, v1
    v_mul_u32_u24 v145, 0xaaaa, v145
    v_add_u32 v145, 0x4444, v145
    v_lshlrev_b32 v12, 4, v12
    v_lshl_add_u32 v12, v13, 11, v12
    s_lshl_b32 s39, s32, 5
    s_add_u32 s39, s39, s34
    s_lshl_b32 s39, s39, 9
    s_add_u32 s39, s39, 0xe1000
    v_add_u32 v20, s39, v12
    v_add_u32 v21, 0x2000, v20
    v_add_u32 v27, 135168, v16
    v_lshlrev_b32 v236, 16, v236
    v_lshlrev_b32 v237, 16, v237
    s_lshl_b32 s39, s32, 5
    s_lshl2_add_u32 s39, s39, 0xd8000
    v_lshl_add_u32 v31, v1, 2, s39
    s_cmp_lt_u32 s53, 6
    s_cbranch_scc1 L_f_prep
    v_add_u32 v28, 0x1000, v31
    s_mov_b64 exec, 0x1
    global_load_dword v255, v28, s[30:31] sc1
    s_mov_b64 exec, -1
    s_branch L_f_ready
L_f_prep:
    s_waitcnt vmcnt(8)
    s_barrier
    ds_read_b64_tr_b16 a[0:1], v24 offset:0
    ds_read_b64_tr_b16 a[2:3], v24 offset:64
    ds_read_b64_tr_b16 a[4:5], v24 offset:2048
    ds_read_b64_tr_b16 a[6:7], v24 offset:2112
    ds_read_b64_tr_b16 a[8:9], v24 offset:4096
    ds_read_b64_tr_b16 a[10:11], v24 offset:4160
    ds_read_b64_tr_b16 a[12:13], v24 offset:6144
    ds_read_b64_tr_b16 a[14:15], v24 offset:6208
    ds_read_b64_tr_b16 a[16:17], v24 offset:8192
    ds_read_b64_tr_b16 a[18:19], v24 offset:8256
    ds_read_b64_tr_b16 a[20:21], v24 offset:10240
    ds_read_b64_tr_b16 a[22:23], v24 offset:10304
    ds_read_b64_tr_b16 a[24:25], v24 offset:12288
    ds_read_b64_tr_b16 a[26:27], v24 offset:12352
    ds_read_b64_tr_b16 a[28:29], v24 offset:14336
    ds_read_b64_tr_b16 a[30:31], v24 offset:14400
    ds_read_b64_tr_b16 a[32:33], v24 offset:16384
    ds_read_b64_tr_b16 a[34:35], v24 offset:16448
    ds_read_b64_tr_b16 a[36:37], v24 offset:18432
    ds_read_b64_tr_b16 a[38:39], v24 offset:18496
    ds_read_b64_tr_b16 a[40:41], v24 offset:20480
    ds_read_b64_tr_b16 a[42:43], v24 offset:20544
    ds_read_b64_tr_b16 a[44:45], v24 offset:22528
    ds_read_b64_tr_b16 a[46:47], v24 offset:22592
    ds_read_b64_tr_b16 a[48:49], v24 offset:24576
    ds_read_b64_tr_b16 a[50:51], v24 offset:24640
    ds_read_b64_tr_b16 a[52:53], v24 offset:26624
    ds_read_b64_tr_b16 a[54:55], v24 offset:26688
    ds_read_b64_tr_b16 a[56:57], v24 offset:28672
    ds_read_b64_tr_b16 a[58:59], v24 offset:28736
    ds_read_b64_tr_b16 a[60:61], v24 offset:30720
    ds_read_b64_tr_b16 a[62:63], v24 offset:30784
    s_waitcnt lgkmcnt(0)
    v_smfmac_f32_16x16x64_bf16 v[52:55], v[232:235], a[0:7], v145
    v_smfmac_f32_16x16x64_bf16 v[52:55], v[232:235], a[8:15], v145
    v_smfmac_f32_16x16x64_bf16 v[52:55], v[232:235], a[16:23], v145
    v_smfmac_f32_16x16x64_bf16 v[52:55], v[232:235], a[24:31], v145
    v_smfmac_f32_16x16x64_bf16 v[52:55], v[232:235], a[32:39], v145
    v_smfmac_f32_16x16x64_bf16 v[52:55], v[232:235], a[40:47], v145
    v_smfmac_f32_16x16x64_bf16 v[52:55], v[232:235], a[48:55], v145
    v_smfmac_f32_16x16x64_bf16 v[52:55], v[232:235], a[56:63], v145
    s_waitcnt vmcnt(0)
    s_barrier
    ds_read_b64_tr_b16 a[64:65], v19 offset:0
    ds_read_b64_tr_b16 a[66:67], v19 offset:4224
    ds_read_b64_tr_b16 a[68:69], v19 offset:32
    ds_read_b64_tr_b16 a[70:71], v19 offset:4256
    ds_read_b64_tr_b16 a[72:73], v19 offset:64
    ds_read_b64_tr_b16 a[74:75], v19 offset:4288
    ds_read_b64_tr_b16 a[76:77], v19 offset:96
    ds_read_b64_tr_b16 a[78:79], v19 offset:4320
    ds_read_b64_tr_b16 a[80:81], v19 offset:128
    ds_read_b64_tr_b16 a[82:83], v19 offset:4352
    ds_read_b64_tr_b16 a[84:85], v19 offset:160
    ds_read_b64_tr_b16 a[86:87], v19 offset:4384
    ds_read_b64_tr_b16 a[88:89], v19 offset:192
    ds_read_b64_tr_b16 a[90:91], v19 offset:4416
    ds_read_b64_tr_b16 a[92:93], v19 offset:224
    ds_read_b64_tr_b16 a[94:95], v19 offset:4448
    v_add_f32 v30, v52, v53
L_f_ready:
    s_mov_b32 s47, 40
    s_mov_b64 exec, 0xff
L_hint_c:
    global_load_dword v13, v31, s[30:31] sc1
    s_waitcnt vmcnt(0)
    v_cmp_ne_u32 vcc, s40, v13
    s_sub_u32 s47, s47, 1
    s_cbranch_scc1 L_hintx_c
    s_cbranch_vccnz L_hint_c
L_hintx_c:
    s_mov_b64 exec, -1
    s_mov_b32 s47, 0x1fffff
    global_load_dwordx4 v[32:35], v20, s[30:31] offset:-4096 sc1
    global_load_dwordx4 v[36:39], v20, s[30:31] offset:0 sc1
    global_load_dwordx4 v[40:43], v21, s[30:31] offset:-4096 sc1
    global_load_dwordx4 v[44:47], v21, s[30:31] offset:0 sc1
    s_branch L_op_wait
L_op_retry:
    s_sub_u32 s47, s47, 1
    s_cbranch_scc1 L_op_done
    s_mov_b64 exec, s[54:55]
    s_cbranch_execz L_op_s0
    global_load_dwordx4 v[32:35], v20, s[30:31] offset:-4096 sc1
L_op_s0:
    s_mov_b64 exec, s[56:57]
    s_cbranch_execz L_op_s1
    global_load_dwordx4 v[36:39], v20, s[30:31] offset:0 sc1
L_op_s1:
    s_mov_b64 exec, s[58:59]
    s_cbranch_execz L_op_s2
    global_load_dwordx4 v[40:43], v21, s[30:31] offset:-4096 sc1
L_op_s2:
    s_mov_b64 exec, s[16:17]
    s_cbranch_execz L_op_s3
    global_load_dwordx4 v[44:47], v21, s[30:31] offset:0 sc1
L_op_s3:
    s_mov_b64 exec, -1
L_op_wait:
    s_waitcnt vmcnt(0)
    v_cmp_ne_u32 s[54:55], s40, v35
    v_cmp_ne_u32 s[56:57], s40, v39
    v_cmp_ne_u32 s[58:59], s40, v43
    v_cmp_ne_u32 s[16:17], s40, v47
    s_or_b64 vcc, s[54:55], s[56:57]
    s_or_b64 vcc, vcc, s[58:59]
    s_or_b64 vcc, vcc, s[16:17]
    s_cbranch_scc1 L_op_retry
L_op_done:
    v_perm_b32 v35, v33, v32, s44
    v_perm_b32 v39, v37, v36, s44
    v_perm_b32 v43, v41, v40, s44
    v_perm_b32 v47, v45, v44, s44
    v_perm_b32 v35, v34, v35, v4
    v_perm_b32 v39, v38, v39, v4
    v_perm_b32 v43, v42, v43, v4
    v_perm_b32 v47, v46, v47, v4
    v_pk_add_f32 v[32:33], v[32:33], v[36:37]
    v_pk_add_f32 v[40:41], v[40:41], v[44:45]
    v_pk_add_f32 v[34:35], v[34:35], v[38:39]
    v_pk_add_f32 v[42:43], v[42:43], v[46:47]
    v_pk_add_f32 v[32:33], v[32:33], v[40:41]
    v_pk_add_f32 v[34:35], v[34:35], v[42:43]
    s_nop 1
    v_permlane32_swap_b32 v32, v34
    v_permlane32_swap_b32 v33, v35
    v_add_f32 v32, v32, v34
    v_add_f32 v33, v33, v35
    v_pk_add_f32 v[32:33], v[32:33], v[236:237]
    v_cvt_pk_bf16_f32 v32, v32, v33
    ds_write_b32 v22, v32
    s_cmp_ge_u32 s53, 6
    s_waitcnt lgkmcnt(0)
    s_barrier
    ds_read_b128 v[52:55], v27
    s_cbranch_scc1 L_final
    ds_read_b128 v[64:67], v23 offset:0
    ds_read_b128 v[68:71], v23 offset:128
    ds_read_b128 v[72:75], v23 offset:256
    ds_read_b128 v[76:79], v23 offset:384
    s_waitcnt lgkmcnt(4)
    v_dot2_f32_bf16 v56, v52, v232, 0
    v_dot2_f32_bf16 v57, v52, v52, 0
    v_dot2_f32_bf16 v56, v53, v232, v56
    v_dot2_f32_bf16 v57, v53, v53, v57
    s_waitcnt lgkmcnt(3)
    v_smfmac_f32_16x16x64_bf16 v[48:51], v[64:67], a[0:7], v145
    ds_read_b128 v[80:83], v23 offset:512
    v_dot2_f32_bf16 v56, v54, v232, v56
    v_dot2_f32_bf16 v57, v54, v54, v57
    s_waitcnt lgkmcnt(3)
    v_smfmac_f32_16x16x64_bf16 v[48:51], v[68:71], a[8:15], v145
    ds_read_b128 v[84:87], v23 offset:640
    v_dot2_f32_bf16 v56, v55, v232, v56
    v_dot2_f32_bf16 v57, v55, v55, v57
    s_waitcnt lgkmcnt(3)
    v_smfmac_f32_16x16x64_bf16 v[48:51], v[72:75], a[16:23], v145
    ds_read_b128 v[88:91], v23 offset:768
    v_add_f32_dpp v56, v56, v56 row_ror:8 row_mask:0xf bank_mask:0xf
    v_add_f32_dpp v57, v57, v57 row_ror:8 row_mask:0xf bank_mask:0xf
    s_waitcnt lgkmcnt(3)
    v_smfmac_f32_16x16x64_bf16 v[48:51], v[76:79], a[24:31], v145
    ds_read_b128 v[92:95], v23 offset:896
    v_add_f32_dpp v56, v56, v56 row_ror:4 row_mask:0xf bank_mask:0xf
    v_add_f32_dpp v57, v57, v57 row_ror:4 row_mask:0xf bank_mask:0xf
    s_waitcnt lgkmcnt(3)
    v_smfmac_f32_16x16x64_bf16 v[48:51], v[80:83], a[32:39], v145
    v_add_f32_dpp v56, v56, v56 row_ror:2 row_mask:0xf bank_mask:0xf
    v_add_f32_dpp v57, v57, v57 row_ror:2 row_mask:0xf bank_mask:0xf
    s_waitcnt lgkmcnt(2)
    v_smfmac_f32_16x16x64_bf16 v[48:51], v[84:87], a[40:47], v145
    v_add_f32_dpp v56, v56, v56 row_ror:1 row_mask:0xf bank_mask:0xf
    v_add_f32_dpp v57, v57, v57 row_ror:1 row_mask:0xf bank_mask:0xf
    s_waitcnt lgkmcnt(1)
    v_smfmac_f32_16x16x64_bf16 v[48:51], v[88:91], a[48:55], v145
    v_add_f32_dpp v56, v56, v56 row_bcast:15 row_mask:0xa bank_mask:0xf
    v_add_f32_dpp v57, v57, v57 row_bcast:15 row_mask:0xa bank_mask:0xf
    s_waitcnt lgkmcnt(0)
    v_smfmac_f32_16x16x64_bf16 v[48:51], v[92:95], a[56:63], v145
    v_add_f32_dpp v56, v56, v56 row_bcast:31 row_mask:0xc bank_mask:0xf
    v_add_f32_dpp v57, v57, v57 row_bcast:31 row_mask:0xc bank_mask:0xf
    v_mul_f32 v56, 0x3b000000, v56
    v_mul_f32 v57, 0x3b000000, v57
    v_fma_f32 v57, -v56, v56, v57
    v_max_f32 v57, 0, v57
    v_add_f32 v57, 0x3727c5ac, v57
    v_rsq_f32 v57, v57
    v_add_f32 v48, v48, v49
    v_mul_f32 v58, 0xbfb8aa3b, v57
    v_fma_f32 v48, -v56, v30, v48
    v_mul_f32 v58, v58, v48
    v_mul_f32 v48, v48, v57
    v_exp_f32 v58, v58
    s_nop 0
    v_mul_f32_dpp v48, v48, v48 row_ror:8 row_mask:0xf bank_mask:0xf
    v_add_f32 v58, 1.0, v58
    v_rcp_f32 v58, v58
    s_mov_b32 exec_lo, 0
    s_mov_b32 exec_hi, 0x00ff0000
    v_mul_f32 v48, v48, v58
    v_cvt_pk_bf16_f32 v48, v48, v48
    ds_write_b16 v25, v48
    s_mov_b64 exec, -1
    s_waitcnt lgkmcnt(0)
    s_barrier
    ds_read_b128 v[60:63], v144
    s_waitcnt lgkmcnt(0)
    v_mfma_f32_16x16x32_bf16 v[64:67], v[60:63], a[64:67], 0
    v_mfma_f32_16x16x32_bf16 v[68:71], v[60:63], a[68:71], 0
    v_mfma_f32_16x16x32_bf16 v[72:75], v[60:63], a[72:75], 0
    v_mfma_f32_16x16x32_bf16 v[76:79], v[60:63], a[76:79], 0
    v_mfma_f32_16x16x32_bf16 v[80:83], v[60:63], a[80:83], 0
    v_mfma_f32_16x16x32_bf16 v[84:87], v[60:63], a[84:87], 0
    v_mfma_f32_16x16x32_bf16 v[88:91], v[60:63], a[88:91], 0
    v_mfma_f32_16x16x32_bf16 v[92:95], v[60:63], a[92:95], 0
    s_nop 3
    v_perm_b32 v148, v64, v76, s41
    v_perm_b32 v149, v68, v76, s42
    v_perm_b32 v150, v72, v76, s43
    s_mov_b32 exec_lo, 0xffff0000
    s_mov_b32 exec_hi, 0
    v_perm_b32 v148, v80, v92, s41
    v_perm_b32 v149, v84, v92, s42
    v_perm_b32 v150, v88, v92, s43
    s_mov_b32 exec_lo, -1
    global_store_dwordx4 v26, v[148:151], s[30:31] sc1
    s_cmp_lg_u32 s34, 0
    s_cbranch_scc1 L_hs_f
    s_mov_b64 exec, 1
    global_store_dword v28, v151, s[30:31]
L_hs_f:
L_idle:
    s_endpgm
L_final:
    s_cmp_eq_u32 s34, 0
    s_cbranch_scc1 L_fin_go
    s_lshl2_add_u32 s39, s2, s34
    s_cmp_lg_u32 s39, 1021
    s_cbranch_scc1 L_idle
    s_add_u32 s45, s45, 1
    s_mov_b64 exec, 1
    v_mov_b32 v44, s45
    v_mov_b32 v46, 0
    global_store_dword v46, v44, s[30:31] sc1
    s_branch L_idle
L_fin_go:
    s_and_b32 s39, s53, 1
    s_lshl1_add_u32 s53, s32, s39
    s_lshl3_add_u32 s48, s32, s39
    s_lshl_b32 s48, s48, 3
    v_lshl_add_u32 v12, v3, 4, s48
    v_add_u32 v12, v12, v15
    v_lshlrev_b32 v45, 1, v12
    v_and_b32 v13, -8, v12
    v_lshl_add_u32 v13, v17, 1, v13
    v_bfe_u32 v12, v12, 2, 1
    v_add_u32 v13, v13, v12
    v_lshlrev_b32 v13, 1, v13
    v_add_u32 v13, 135168, v13
    ds_read_u16 v60, v13
    s_lshl_b32 s39, s53, 7
    s_add_u32 s39, s39, 0x80000
    v_lshl_add_u32 v47, v15, 4, s39
    v_add_u32 v12, 0, v14
    v_lshl_add_u32 v136, v12, 11, v47
    v_add_u32 v12, 8, v14
    v_lshl_add_u32 v137, v12, 11, v47
    v_add_u32 v12, 16, v14
    v_lshl_add_u32 v138, v12, 11, v47
    v_add_u32 v12, 24, v14
    v_lshl_add_u32 v139, v12, 11, v47
    v_add_u32 v12, 32, v14
    v_lshl_add_u32 v140, v12, 11, v47
    v_add_u32 v12, 40, v14
    v_min_u32 v12, 42, v12
    v_lshl_add_u32 v141, v12, 11, v47
    s_mov_b32 s39, 0x05040100
    s_mov_b32 s48, 0x07060302
    v_perm_b32 v244, v242, v240, s39
    v_perm_b32 v245, v242, v240, s48
    v_perm_b32 v246, v243, v241, s39
    v_perm_b32 v247, v243, v241, s48
    s_waitcnt lgkmcnt(0)
    v_dot2_f32_bf16 v62, v52, v244, 0
    v_dot2_f32_bf16 v63, v240, v232, 0
    v_dot2_f32_bf16 v62, v53, v245, v62
    v_dot2_f32_bf16 v63, v241, v232, v63
    v_dot2_f32_bf16 v62, v54, v246, v62
    v_dot2_f32_bf16 v63, v242, v232, v63
    v_dot2_f32_bf16 v62, v55, v247, v62
    v_dot2_f32_bf16 v63, v243, v232, v63
    v_dot2_f32_bf16 v56, v52, v232, 0
    v_dot2_f32_bf16 v57, v52, v52, 0
    v_dot2_f32_bf16 v56, v53, v232, v56
    v_dot2_f32_bf16 v57, v53, v53, v57
    v_dot2_f32_bf16 v56, v54, v232, v56
    v_dot2_f32_bf16 v57, v54, v54, v57
    v_dot2_f32_bf16 v56, v55, v232, v56
    v_dot2_f32_bf16 v57, v55, v55, v57
    s_nop 1
    v_add_f32_dpp v56, v56, v56 row_ror:8 row_mask:0xf bank_mask:0xf
    v_add_f32_dpp v57, v57, v57 row_ror:8 row_mask:0xf bank_mask:0xf
    s_nop 0
    v_add_f32_dpp v56, v56, v56 row_ror:4 row_mask:0xf bank_mask:0xf
    v_add_f32_dpp v57, v57, v57 row_ror:4 row_mask:0xf bank_mask:0xf
    s_nop 0
    v_add_f32_dpp v56, v56, v56 row_ror:2 row_mask:0xf bank_mask:0xf
    v_add_f32_dpp v57, v57, v57 row_ror:2 row_mask:0xf bank_mask:0xf
    s_nop 0
    v_add_f32_dpp v56, v56, v56 row_ror:1 row_mask:0xf bank_mask:0xf
    v_add_f32_dpp v57, v57, v57 row_ror:1 row_mask:0xf bank_mask:0xf
    v_mov_b32 v58, v56
    v_mov_b32 v59, v57
    s_nop 0
    v_permlane16_swap_b32 v56, v58
    v_permlane16_swap_b32 v57, v59
    v_add_f32 v56, v56, v58
    v_add_f32 v57, v57, v59
    v_mov_b32 v58, v56
    v_mov_b32 v59, v57
    s_nop 0
    v_permlane32_swap_b32 v56, v58
    v_permlane32_swap_b32 v57, v59
    v_add_f32 v56, v56, v58
    v_add_f32 v57, v57, v59
    v_mul_f32 v56, 0x3b000000, v56
    v_mul_f32 v57, 0x3b000000, v57
    v_fma_f32 v57, -v56, v56, v57
    v_max_f32 v57, 0, v57
    v_add_f32 v57, 0x3727c5ac, v57
    v_rsq_f32 v57, v57
    v_fma_f32 v62, -v56, v63, v62
    s_nop 1
    v_add_f32_dpp v62, v62, v62 row_ror:8 row_mask:0xf bank_mask:0xf
    s_nop 1
    v_add_f32_dpp v62, v62, v62 row_ror:4 row_mask:0xf bank_mask:0xf
    s_nop 1
    v_add_f32_dpp v62, v62, v62 row_ror:2 row_mask:0xf bank_mask:0xf
    s_nop 1
    v_add_f32_dpp v62, v62, v62 row_ror:1 row_mask:0xf bank_mask:0xf
    v_mov_b32 v63, v62
    s_nop 1
    v_permlane16_swap_b32 v62, v63
    v_add_f32 v62, v62, v63
    v_mov_b32 v63, v62
    s_nop 1
    v_permlane32_swap_b32 v62, v63
    v_add_f32 v62, v62, v63
    v_mul_f32 v62, v62, v57
    v_mul_f32 v62, 0xbfb8aa3b, v62
    v_exp_f32 v62, v62
    v_lshlrev_b32 v60, 16, v60
    v_add_f32 v62, 1.0, v62
    v_rcp_f32 v61, v62
    v_sub_f32 v63, v60, v56
    v_fmac_f32 v60, v63, v57
    v_cmp_gt_u32 vcc, 3, v14
    s_nop 1
    v_cndmask_b32 v62, 0, 1.0, vcc
    v_cndmask_b32 v63, 0, 1.0, vcc
    s_mov_b32 s47, 12
    s_mov_b64 exec, 0x1f
L_hint_d:
    global_load_dword v13, v28, s[30:31] sc1
    s_waitcnt vmcnt(0)
    v_cmp_ne_u32 vcc, s40, v13
    s_sub_u32 s47, s47, 1
    s_cbranch_scc1 L_hintx_d
    s_cbranch_vccnz L_hint_d
L_hintx_d:
    s_mov_b64 exec, -1
    s_mov_b32 s47, 0x1fffff
    global_load_dwordx4 v[96:99], v136, s[30:31] sc1
    global_load_dwordx4 v[100:103], v137, s[30:31] sc1
    global_load_dwordx4 v[104:107], v138, s[30:31] sc1
    global_load_dwordx4 v[108:111], v139, s[30:31] sc1
    global_load_dwordx4 v[112:115], v140, s[30:31] sc1
    global_load_dwordx4 v[116:119], v141, s[30:31] sc1
    s_branch L_yp_wait
L_yp_retry:
    s_sub_u32 s47, s47, 1
    s_cbranch_scc1 L_yp_done
    s_mov_b64 exec, s[54:55]
    s_cbranch_execz L_yp_s0
    global_load_dwordx4 v[96:99], v136, s[30:31] sc1
L_yp_s0:
    s_mov_b64 exec, s[56:57]
    s_cbranch_execz L_yp_s1
    global_load_dwordx4 v[100:103], v137, s[30:31] sc1
L_yp_s1:
    s_mov_b64 exec, s[58:59]
    s_cbranch_execz L_yp_s2
    global_load_dwordx4 v[104:107], v138, s[30:31] sc1
L_yp_s2:
    s_mov_b64 exec, s[16:17]
    s_cbranch_execz L_yp_s3
    global_load_dwordx4 v[108:111], v139, s[30:31] sc1
L_yp_s3:
    s_mov_b64 exec, s[18:19]
    s_cbranch_execz L_yp_s4
    global_load_dwordx4 v[112:115], v140, s[30:31] sc1
L_yp_s4:
    s_mov_b64 exec, s[20:21]
    s_cbranch_execz L_yp_s5
    global_load_dwordx4 v[116:119], v141, s[30:31] sc1
L_yp_s5:
    s_mov_b64 exec, -1
L_yp_wait:
    s_waitcnt vmcnt(0)
    v_cmp_ne_u32 s[54:55], s40, v99
    v_cmp_ne_u32 s[56:57], s40, v103
    v_cmp_ne_u32 s[58:59], s40, v107
    v_cmp_ne_u32 s[16:17], s40, v111
    v_cmp_ne_u32 s[18:19], s40, v115
    v_cmp_ne_u32 s[20:21], s40, v119
    s_or_b64 vcc, s[54:55], s[56:57]
    s_or_b64 vcc, vcc, s[58:59]
    s_or_b64 vcc, vcc, s[16:17]
    s_or_b64 vcc, vcc, s[18:19]
    s_or_b64 vcc, vcc, s[20:21]
    s_cbranch_scc1 L_yp_retry
L_yp_done:
    v_perm_b32 v99, v97, v96, s44
    v_perm_b32 v103, v101, v100, s44
    v_perm_b32 v107, v105, v104, s44
    v_perm_b32 v111, v109, v108, s44
    v_perm_b32 v115, v113, v112, s44
    v_perm_b32 v119, v117, v116, s44
    v_perm_b32 v99, v98, v99, v4
    v_perm_b32 v103, v102, v103, v4
    v_perm_b32 v107, v106, v107, v4
    v_perm_b32 v111, v110, v111, v4
    v_perm_b32 v115, v114, v115, v4
    v_perm_b32 v119, v118, v119, v4
    v_pk_add_f32 v[96:97], v[96:97], v[100:101]
    v_pk_add_f32 v[104:105], v[104:105], v[108:109]
    v_pk_fma_f32 v[112:113], v[116:117], v[62:63], v[112:113]
    v_pk_add_f32 v[98:99], v[98:99], v[102:103]
    v_pk_add_f32 v[106:107], v[106:107], v[110:111]
    v_pk_fma_f32 v[114:115], v[118:119], v[62:63], v[114:115]
    v_pk_add_f32 v[96:97], v[96:97], v[104:105]
    v_pk_add_f32 v[98:99], v[98:99], v[106:107]
    v_pk_add_f32 v[96:97], v[96:97], v[112:113]
    v_pk_add_f32 v[98:99], v[98:99], v[114:115]
    s_nop 1
    v_permlane32_swap_b32 v96, v98
    v_permlane32_swap_b32 v97, v99
    v_add_f32 v96, v96, v98
    v_add_f32 v97, v97, v99
    s_nop 1
    v_permlane16_swap_b32 v96, v97
    v_add_f32 v96, v96, v97
    s_nop 1
    v_add_f32_dpp v96, v96, v96 row_ror:8 row_mask:0xf bank_mask:0xf
    s_mov_b32 exec_lo, 0xff00ff
    s_mov_b32 exec_hi, 0xff00ff
    v_fmac_f32 v60, v96, v61
    v_cvt_pk_bf16_f32 v60, v60, v60
    global_store_short v45, v60, s[26:27]
    s_endpgm
.p2align 12
L_roleO:
L_pf_q1:
    s_cbranch_execz L_pf_q_ret
    s_lshl3_add_u32 s39, s32, s36
    s_lshl2_add_u32 s39, s39, s34
    s_lshl_b32 s39, s39, 6
    s_add_u32 s39, s39, 0xe0000
    v_lshl_add_u32 v21, v17, 4, s39
    v_lshl_add_u32 v21, v3, 14, v21
    v_add_u32 v25, 0x10000, v21
    s_not_b32 s39, s40
    v_mov_b32 v44, s39
    v_mov_b32 v45, s39
    v_mov_b32 v46, s39
    v_mov_b32 v47, s39
    s_mov_b32 exec_lo, 0xf000f
    s_mov_b32 exec_hi, 0xf000f
    global_store_dwordx4 v21, v[44:47], s[30:31] sc1
    global_store_dwordx4 v25, v[44:47], s[30:31] sc1
    s_mov_b64 exec, -1
    s_lshl2_add_u32 s49, s32, s34
    s_lshl_b32 s48, s49, 17
    s_lshl_b32 s39, s36, 7
    s_add_u32 s48, s48, s39
    v_lshlrev_b32 v12, 10, v14
    v_lshlrev_b32 v13, 1, v3
    v_xor_b32 v13, v13, v15
    v_lshl_add_u32 v12, v13, 4, v12
    v_add_u32 v12, s48, v12
    s_mul_i32 m0, s34, 18432
    s_add_u32 s62, s30, 0x60000
    s_addc_u32 s63, s31, 0
    s_lshl_b32 s39, s49, 11
    s_add_u32 s39, s39, 0x60000
    v_add_u32 v20, s39, v16
    v_lshl_add_u32 v13, v1, 7, s39
    s_mov_b64 exec, 0xffff
    global_load_dword v255, v13, s[62:63] sc1
    s_mov_b64 exec, -1
    global_load_lds_dwordx4 v12, s[14:15]
    s_add_u32 m0, m0, 1152
    v_add_u32 v12, s3, v12
    global_load_lds_dwordx4 v12, s[14:15]
    s_add_u32 m0, m0, 1152
    v_add_u32 v12, s3, v12
    global_load_lds_dwordx4 v12, s[14:15]
    s_add_u32 m0, m0, 1152
    v_add_u32 v12, s3, v12
    global_load_lds_dwordx4 v12, s[14:15]
    s_add_u32 m0, m0, 1152
    v_add_u32 v12, s3, v12
    global_load_lds_dwordx4 v12, s[14:15]
    s_add_u32 m0, m0, 1152
    v_add_u32 v12, s3, v12
    global_load_lds_dwordx4 v12, s[14:15]
    s_add_u32 m0, m0, 1152
    v_add_u32 v12, s3, v12
    global_load_lds_dwordx4 v12, s[14:15]
    s_add_u32 m0, m0, 1152
    v_add_u32 v12, s3, v12
    global_load_lds_dwordx4 v12, s[14:15]
    s_add_u32 m0, m0, 1152
    v_add_u32 v12, s3, v12
    global_load_lds_dwordx4 v12, s[14:15]
    s_add_u32 m0, m0, 1152
    v_add_u32 v12, s3, v12
    global_load_lds_dwordx4 v12, s[14:15]
    s_add_u32 m0, m0, 1152
    v_add_u32 v12, s3, v12
    global_load_lds_dwordx4 v12, s[14:15]
    s_add_u32 m0, m0, 1152
    v_add_u32 v12, s3, v12
    global_load_lds_dwordx4 v12, s[14:15]
    s_add_u32 m0, m0, 1152
    v_add_u32 v12, s3, v12
    global_load_lds_dwordx4 v12, s[14:15]
    s_add_u32 m0, m0, 1152
    v_add_u32 v12, s3, v12
    global_load_lds_dwordx4 v12, s[14:15]
    s_add_u32 m0, m0, 1152
    v_add_u32 v12, s3, v12
    global_load_lds_dwordx4 v12, s[14:15]
    s_add_u32 m0, m0, 1152
    v_add_u32 v12, s3, v12
    global_load_lds_dwordx4 v12, s[14:15]
    v_and_b32 v12, 31, v1
    v_lshrrev_b32 v13, 5, v1
    v_lshrrev_b32 v18, 2, v12
    v_lshl_add_u32 v18, v18, 1, v13
    v_lshl_add_u32 v18, v18, 2, v17
    s_lshl_b32 s39, s34, 8
    s_add_u32 s39, s39, 135168
    v_lshl_add_u32 v22, v18, 2, s39
    v_and_b32 v18, 1, v1
    v_lshl_add_u32 v18, v3, 1, v18
    v_lshlrev_b32 v23, 4, v18
    v_add_u32 v23, 135168, v23
    v_and_b32 v27, 1, v1
    v_mul_u32_u24 v27, 0xaaaa, v27
    v_add_u32 v27, 0x4444, v27
    s_lshl_b32 s39, s32, 5
    s_add_u32 s39, s39, s36
    s_lshl2_add_u32 s39, s39, 0xd8000
    v_lshl_add_u32 v26, v1, 2, s39
    v_lshrrev_b32 v18, 2, v2
    v_and_b32 v12, 2, v3
    v_lshrrev_b32 v13, 1, v18
    v_add_u32 v12, v12, v13
    v_mul_u32_u24 v12, 1152, v12
    v_and_b32 v13, 1, v18
    v_and_b32 v18, 1, v3
    v_lshl_add_u32 v13, v13, 1, v18
    v_lshl_add_u32 v12, v13, 8, v12
    v_xor_b32 v13, s34, v13
    v_lshl_add_u32 v12, v13, 5, v12
    v_lshl_add_u32 v24, v17, 3, v12
    v_add_u32 v19, 36864, v24
    v_mov_b32 v51, s40
    v_mov_b32 v40, 0
    v_mov_b32 v41, 0
    v_mov_b32 v42, 0
    v_mov_b32 v43, 0
    s_waitcnt vmcnt(0)
    s_barrier
    ds_read_b64_tr_b16 a[0:1], v24 offset:0
    ds_read_b64_tr_b16 a[2:3], v24 offset:128
    ds_read_b64_tr_b16 a[4:5], v24 offset:4608
    ds_read_b64_tr_b16 a[6:7], v24 offset:4736
    ds_read_b64_tr_b16 a[8:9], v24 offset:9216
    ds_read_b64_tr_b16 a[10:11], v24 offset:9344
    ds_read_b64_tr_b16 a[12:13], v24 offset:13824
    ds_read_b64_tr_b16 a[14:15], v24 offset:13952
    ds_read_b64_tr_b16 a[16:17], v24 offset:18432
    ds_read_b64_tr_b16 a[18:19], v24 offset:18560
    ds_read_b64_tr_b16 a[20:21], v24 offset:23040
    ds_read_b64_tr_b16 a[22:23], v24 offset:23168
    ds_read_b64_tr_b16 a[24:25], v24 offset:27648
    ds_read_b64_tr_b16 a[26:27], v24 offset:27776
    ds_read_b64_tr_b16 a[28:29], v24 offset:32256
    ds_read_b64_tr_b16 a[30:31], v24 offset:32384
    ds_read_b64_tr_b16 a[32:33], v19 offset:0
    ds_read_b64_tr_b16 a[34:35], v19 offset:128
    ds_read_b64_tr_b16 a[36:37], v19 offset:4608
    ds_read_b64_tr_b16 a[38:39], v19 offset:4736
    ds_read_b64_tr_b16 a[40:41], v19 offset:9216
    ds_read_b64_tr_b16 a[42:43], v19 offset:9344
    ds_read_b64_tr_b16 a[44:45], v19 offset:13824
    ds_read_b64_tr_b16 a[46:47], v19 offset:13952
    ds_read_b64_tr_b16 a[48:49], v19 offset:18432
    ds_read_b64_tr_b16 a[50:51], v19 offset:18560
    ds_read_b64_tr_b16 a[52:53], v19 offset:23040
    ds_read_b64_tr_b16 a[54:55], v19 offset:23168
    ds_read_b64_tr_b16 a[56:57], v19 offset:27648
    ds_read_b64_tr_b16 a[58:59], v19 offset:27776
    ds_read_b64_tr_b16 a[60:61], v19 offset:32256
    ds_read_b64_tr_b16 a[62:63], v19 offset:32384
    s_mov_b32 s47, 0x1fffff
    s_mov_b64 s[60:61], s[62:63]
    global_load_dwordx4 v[32:35], v20, s[60:61] offset:0 sc1
    global_load_dwordx4 v[36:39], v20, s[60:61] offset:1024 sc1
    s_branch L_cp_wait
L_cp_retry:
    s_sub_u32 s47, s47, 1
    s_cbranch_scc1 L_cp_done
    s_cmp_gt_u32 s47, 0x1fffe3
    s_cselect_b64 s[60:61], s[62:63], s[30:31]
    s_mov_b64 exec, s[54:55]
    s_cbranch_execz L_cp_s0
    global_load_dwordx4 v[32:35], v20, s[60:61] offset:0 sc1
L_cp_s0:
    s_mov_b64 exec, s[56:57]
    s_cbranch_execz L_cp_s1
    global_load_dwordx4 v[36:39], v20, s[60:61] offset:1024 sc1
L_cp_s1:
    s_mov_b64 exec, -1
L_cp_wait:
    s_waitcnt vmcnt(0)
    v_cmp_ne_u32 s[54:55], s40, v35
    v_cmp_ne_u32 s[56:57], s40, v39
    s_or_b64 vcc, s[54:55], s[56:57]
    s_cbranch_scc1 L_cp_retry
L_cp_done:
    v_perm_b32 v35, v33, v32, s44
    v_perm_b32 v39, v37, v36, s44
    v_perm_b32 v35, v34, v35, v4
    v_perm_b32 v39, v38, v39, v4
    v_pk_add_f32 v[32:33], v[32:33], v[36:37]
    v_pk_add_f32 v[34:35], v[34:35], v[38:39]
    s_nop 1
    v_permlane32_swap_b32 v32, v34
    v_permlane32_swap_b32 v33, v35
    v_add_f32 v32, v32, v34
    v_add_f32 v33, v33, v35
    v_cvt_pk_bf16_f32 v32, v32, v33
    ds_write_b32 v22, v32
    s_waitcnt lgkmcnt(0)
    s_barrier
    ds_read_b128 v[64:67], v23 offset:0
    ds_read_b128 v[68:71], v23 offset:128
    ds_read_b128 v[72:75], v23 offset:256
    ds_read_b128 v[76:79], v23 offset:384
    s_waitcnt lgkmcnt(3)
    v_smfmac_f32_16x16x64_bf16 v[40:43], v[64:67], a[0:7], v27
    ds_read_b128 v[80:83], v23 offset:512
    s_waitcnt lgkmcnt(3)
    v_smfmac_f32_16x16x64_bf16 v[40:43], v[68:71], a[8:15], v27
    ds_read_b128 v[84:87], v23 offset:640
    s_waitcnt lgkmcnt(3)
    v_smfmac_f32_16x16x64_bf16 v[40:43], v[72:75], a[16:23], v27
    ds_read_b128 v[88:91], v23 offset:768
    s_waitcnt lgkmcnt(3)
    v_smfmac_f32_16x16x64_bf16 v[40:43], v[76:79], a[24:31], v27
    ds_read_b128 v[92:95], v23 offset:896
    s_waitcnt lgkmcnt(3)
    v_smfmac_f32_16x16x64_bf16 v[40:43], v[80:83], a[32:39], v27
    s_waitcnt lgkmcnt(2)
    v_smfmac_f32_16x16x64_bf16 v[40:43], v[84:87], a[40:47], v27
    s_waitcnt lgkmcnt(1)
    v_smfmac_f32_16x16x64_bf16 v[40:43], v[88:91], a[48:55], v27
    s_waitcnt lgkmcnt(0)
    v_smfmac_f32_16x16x64_bf16 v[40:43], v[92:95], a[56:63], v27
    s_cmp_lg_u32 s34, 0
    s_cbranch_scc1 L_hs_o
    s_mov_b64 exec, 1
    global_store_dword v26, v51, s[30:31]
    s_mov_b64 exec, -1
L_hs_o:
    s_nop 5
    v_add_f32 v40, v40, v41
    s_nop 1
    v_mov_b32_dpp v43, v40 row_shl:12 row_mask:0xf bank_mask:0xf
    v_mov_b32_dpp v41, v40 row_shl:4 row_mask:0xf bank_mask:0xf
    v_mov_b32_dpp v42, v40 row_shl:8 row_mask:0xf bank_mask:0xf
    v_perm_b32 v48, v40, v43, s41
    v_perm_b32 v49, v41, v43, s42
    v_perm_b32 v50, v42, v43, s43
    s_mov_b32 exec_lo, 0xf000f
    s_mov_b32 exec_hi, 0xf000f
    global_store_dwordx4 v21, v[48:51], s[30:31] sc1
    global_store_dwordx4 v25, v[48:51], s[30:31] sc1
    s_endpgm
.p2align 12
L_roleN:
L_pf_n0:
    s_cbranch_execz L_pf_n_ret
    global_load_dwordx4 v[60:63], v76, s[10:11] nt
    v_add_u32 v76, s3, v76
    global_load_dwordx4 v[64:67], v76, s[10:11] nt
    v_add_u32 v76, s3, v76
    global_load_dwordx4 v[68:71], v76, s[10:11] nt
    v_add_u32 v76, s3, v76
    global_load_dwordx4 v[72:75], v76, s[10:11] nt
    s_lshl_b32 s39, s58, 9
    s_add_u32 s39, s39, s59
    s_lshl2_add_u32 s39, s39, 0x20000
    v_lshl_add_u32 v79, v15, 4, s39
    v_lshlrev_b32 v27, 5, v15
    s_and_b32 s39, s36, 1
    s_mul_i32 s39, s39, 6144
    s_add_u32 s39, s39, s52
    s_add_u32 s39, s39, 20480
    v_min_u32 v20, 47, v1
    v_lshl_add_u32 v20, v20, 7, s39
    s_waitcnt vmcnt(2)
    s_mov_b32 s47, 0x1fffff
    s_mov_b64 s[60:61], s[62:63]
    global_load_dwordx4 v[80:83], v26, s[60:61] offset:0 sc1
    global_load_dwordx4 v[84:87], v26, s[60:61] offset:128 sc1
    s_branch L_q_wait
L_q_retry:
    s_sub_u32 s47, s47, 1
    s_cbranch_scc1 L_q_done
    s_cmp_lg_u32 s47, 0x1fffeb
    s_cbranch_scc1 L_q_keep
    s_mov_b64 s[60:61], s[30:31]
    s_mov_b32 exec_lo, 0xf000f
    s_mov_b32 exec_hi, 0xf000f
    global_store_dwordx4 v78, v[116:119], s[30:31] sc1
    s_mov_b64 exec, -1
L_q_keep:
    s_mov_b64 exec, s[54:55]
    s_cbranch_execz L_q_s0
    global_load_dwordx4 v[80:83], v26, s[60:61] offset:0 sc1
L_q_s0:
    s_mov_b64 exec, s[56:57]
    s_cbranch_execz L_q_s1
    global_load_dwordx4 v[84:87], v26, s[60:61] offset:128 sc1
L_q_s1:
    s_mov_b64 exec, -1
L_q_wait:
    s_waitcnt vmcnt(0)
    v_cmp_ne_u32 s[54:55], s40, v83
    v_cmp_ne_u32 s[56:57], s40, v87
    s_or_b64 vcc, s[54:55], s[56:57]
    s_cbranch_scc1 L_q_retry
L_q_done:
    s_barrier
    s_mov_b32 exec_lo, 0xffffffff
    s_mov_b32 exec_hi, 0xffff
    global_load_dword v255, v20, s[6:7]
    s_mov_b64 exec, -1
    v_perm_b32 v83, v81, v80, s44
    v_perm_b32 v87, v85, v84, s44
    v_perm_b32 v83, v82, v83, v4
    v_perm_b32 v87, v86, v87, v4
    v_permlane32_swap_b32 v80, v84
    v_permlane32_swap_b32 v81, v85
    v_permlane32_swap_b32 v82, v86
    v_permlane32_swap_b32 v83, v87
    v_add_f32 v80, v80, v84
    v_add_f32 v81, v81, v85
    v_add_f32 v82, v82, v86
    v_add_f32 v83, v83, v87
    s_nop 0
    v_permlane16_swap_b32 v80, v82
    v_permlane16_swap_b32 v81, v83
    v_add_f32 v80, v80, v82
    v_add_f32 v81, v81, v83
    v_cvt_pk_bf16_f32 v28, v80, v81
    v_cvt_pk_bf16_f32 v29, v80, v81
    s_nop 1
    v_permlane16_swap_b32 v28, v29
    v_mov_b32 v30, v28
    v_mov_b32 v31, v29
    s_nop 0
    v_permlane32_swap_b32 v28, v30
    v_permlane32_swap_b32 v29, v31
    v_dot2_f32_bf16 v32, v44, v28, 0
    v_dot2_f32_bf16 v33, v48, v28, 0
    v_dot2_f32_bf16 v34, v52, v28, 0
    v_dot2_f32_bf16 v35, v56, v28, 0
    v_dot2_f32_bf16 v36, v60, v28, 0
    v_dot2_f32_bf16 v37, v64, v28, 0
    v_dot2_f32_bf16 v38, v68, v28, 0
    v_dot2_f32_bf16 v39, v72, v28, 0
    v_dot2_f32_bf16 v32, v45, v29, v32
    v_dot2_f32_bf16 v33, v49, v29, v33
    v_dot2_f32_bf16 v34, v53, v29, v34
    v_dot2_f32_bf16 v35, v57, v29, v35
    v_dot2_f32_bf16 v36, v61, v29, v36
    v_dot2_f32_bf16 v37, v65, v29, v37
    v_dot2_f32_bf16 v38, v69, v29, v38
    v_dot2_f32_bf16 v39, v73, v29, v39
    v_dot2_f32_bf16 v32, v46, v30, v32
    v_dot2_f32_bf16 v33, v50, v30, v33
    v_dot2_f32_bf16 v34, v54, v30, v34
    v_dot2_f32_bf16 v35, v58, v30, v35
    v_dot2_f32_bf16 v36, v62, v30, v36
    v_dot2_f32_bf16 v37, v66, v30, v37
    v_dot2_f32_bf16 v38, v70, v30, v38
    v_dot2_f32_bf16 v39, v74, v30, v39
    v_dot2_f32_bf16 v32, v47, v31, v32
    v_dot2_f32_bf16 v33, v51, v31, v33
    v_dot2_f32_bf16 v34, v55, v31, v34
    v_dot2_f32_bf16 v35, v59, v31, v35
    v_dot2_f32_bf16 v36, v63, v31, v36
    v_dot2_f32_bf16 v37, v67, v31, v37
    v_dot2_f32_bf16 v38, v71, v31, v38
    v_dot2_f32_bf16 v39, v75, v31, v39
    v_add_f32_dpp v40, v32, v32 row_ror:8 row_mask:0xf bank_mask:0x3
    v_add_f32_dpp v41, v33, v33 row_ror:8 row_mask:0xf bank_mask:0x3
    v_add_f32_dpp v42, v34, v34 row_ror:8 row_mask:0xf bank_mask:0x3
    v_add_f32_dpp v43, v35, v35 row_ror:8 row_mask:0xf bank_mask:0x3
    v_add_f32_dpp v40, v36, v36 row_ror:8 row_mask:0xf bank_mask:0xc
    v_add_f32_dpp v41, v37, v37 row_ror:8 row_mask:0xf bank_mask:0xc
    v_add_f32_dpp v42, v38, v38 row_ror:8 row_mask:0xf bank_mask:0xc
    v_add_f32_dpp v43, v39, v39 row_ror:8 row_mask:0xf bank_mask:0xc
    v_add_f32_dpp v40, v40, v40 row_half_mirror row_mask:0xf bank_mask:0xf
    v_add_f32_dpp v41, v41, v41 row_half_mirror row_mask:0xf bank_mask:0xf
    v_add_f32_dpp v42, v42, v42 row_half_mirror row_mask:0xf bank_mask:0xf
    v_add_f32_dpp v43, v43, v43 row_half_mirror row_mask:0xf bank_mask:0xf
    v_add_f32_dpp v40, v40, v40 quad_perm:[1,0,3,2] row_mask:0xf bank_mask:0xf
    v_add_f32_dpp v41, v41, v41 quad_perm:[1,0,3,2] row_mask:0xf bank_mask:0xf
    v_add_f32_dpp v42, v42, v42 quad_perm:[1,0,3,2] row_mask:0xf bank_mask:0xf
    v_add_f32_dpp v43, v43, v43 quad_perm:[1,0,3,2] row_mask:0xf bank_mask:0xf
    v_add_f32_dpp v40, v40, v40 quad_perm:[2,3,0,1] row_mask:0xf bank_mask:0xf
    v_add_f32_dpp v41, v41, v41 quad_perm:[2,3,0,1] row_mask:0xf bank_mask:0xf
    v_add_f32_dpp v42, v42, v42 quad_perm:[2,3,0,1] row_mask:0xf bank_mask:0xf
    v_add_f32_dpp v43, v43, v43 quad_perm:[2,3,0,1] row_mask:0xf bank_mask:0xf
    v_cvt_pk_bf16_f32 v40, v40, v41
    v_cvt_pk_bf16_f32 v41, v42, v43
    ds_bpermute_b32 v40, v27, v40
    ds_bpermute_b32 v41, v27, v41
    v_mov_b32 v42, s40
    s_mov_b64 exec, 0xff
    s_waitcnt lgkmcnt(0)
    global_store_dwordx4 v79, v[40:43], s[30:31] sc1
    s_mov_b64 exec, s[48:49]
    global_store_dwordx4 v78, v[116:119], s[30:31] sc1
    s_mov_b64 exec, -1
    v_add_u32 v12, s38, v3
    s_lshl_b32 s39, s35, 8
    v_lshrrev_b32 v13, 1, v1
    v_and_b32 v16, 8, v13
    v_xor_b32 v13, v16, v2
    v_lshl_add_u32 v13, v13, 4, s39
    v_lshl_add_u32 v12, v12, 13, v13
    s_mul_i32 m0, s34, 8256
    s_mul_i32 s46, s32, 43
    s_add_u32 s48, s46, 43
    s_lshr_b32 s46, s46, 3
    s_lshr_b32 s48, s48, 3
    s_lshl2_add_u32 s49, s36, s34
    v_bfe_u32 v160, v1, 2, 3
    v_lshl_add_u32 v160, s49, 3, v160
    v_mul_u32_u24 v160, 2752, v160
    s_lshl_b32 s39, s46, 6
    v_lshl_add_u32 v13, v17, 7, s39
    s_lshl_b32 s39, s48, 6
    s_sub_u32 s39, s39, 4
    v_min_u32 v13, s39, v13
    v_add_u32 v160, v160, v13
    s_sub_u32 s48, s48, s46
    s_lshl_b32 s48, s48, 2
    s_mul_i32 s49, s49, s48
    s_lshl_b32 s39, s46, 8
    s_add_u32 s39, s39, s49
    v_add_u32 v161, s39, v1
    v_lshlrev_b32 v161, 7, v161
    s_bfm_b64 s[96:97], s48, 0
    s_waitcnt vmcnt(2)
    s_barrier
    global_load_lds_dwordx4 v12, s[12:13] nt
    s_add_u32 m0, m0, 1024
    v_add_u32 v12, 0x8000, v12
    global_load_lds_dwordx4 v12, s[12:13] nt
    s_add_u32 m0, m0, 1024
    v_add_u32 v12, 0x8000, v12
    global_load_lds_dwordx4 v12, s[12:13] nt
    s_add_u32 m0, m0, 1024
    v_add_u32 v12, 0x8000, v12
    global_load_lds_dwordx4 v12, s[12:13] nt
    s_add_u32 m0, m0, 1056
    v_add_u32 v12, 0x8000, v12
    global_load_lds_dwordx4 v12, s[12:13] nt
    s_add_u32 m0, m0, 1024
    v_add_u32 v12, 0x8000, v12
    global_load_lds_dwordx4 v12, s[12:13] nt
    s_add_u32 m0, m0, 1024
    v_add_u32 v12, 0x8000, v12
    global_load_lds_dwordx4 v12, s[12:13] nt
    s_add_u32 m0, m0, 1024
    v_add_u32 v12, 0x8000, v12
    global_load_lds_dwordx4 v12, s[12:13] nt
    s_mov_b32 exec_lo, 0xffffffff
    s_mov_b32 exec_hi, 0x0
    global_load_dword v255, v160, s[20:21]
    s_mov_b64 exec, -1
    s_add_u32 s62, s30, 0x60000
    s_addc_u32 s63, s31, 0
    v_lshl_add_u32 v12, v17, 2, v3
    s_and_b32 s39, s32, 3
    s_lshl2_add_u32 s39, s39, s34
    s_lshl_b32 s39, s39, 12
    s_lshl3_add_u32 s39, s35, s39
    s_add_u32 s39, s39, 0x40000
    v_lshl_add_u32 v20, v12, 8, s39
    s_and_b32 s48, s36, 3
    s_lshr_b32 s49, s35, 4
    s_lshl2_add_u32 s49, s49, s48
    s_lshl_b32 s49, s49, 7
    s_and_b32 s39, s35, 15
    s_lshl3_add_u32 s49, s39, s49
    s_lshl_b32 s39, s34, 14
    s_add_u32 s49, s49, s39
    s_add_u32 s49, s49, 0x300000
    v_lshl_add_u32 v22, v12, 10, s49
    s_lshl2_add_u32 s48, s35, s48
    s_lshl2_add_u32 s39, s48, s34
    s_lshl_b32 s49, s39, 12
    s_add_u32 s49, s49, 0x100000
    v_lshl_add_u32 v21, v1, 4, s49
    s_lshl_b32 s49, s39, 7
    s_add_u32 s49, s49, 0x60000
    v_lshl_add_u32 v28, v7, 4, s49
    v_lshrrev_b32 v18, 2, v2
    s_lshl_b32 s39, s34, 8
    s_add_u32 s39, s39, 33792
    v_lshl_add_u32 v23, v1, 2, s39
    v_add_u32 v12, s34, v18
    v_and_b32 v12, 3, v12
    v_and_b32 v13, 0x33, v1
    v_lshl_add_u32 v12, v12, 6, v13
    v_lshlrev_b32 v12, 2, v12
    v_add_u32 v24, 33792, v12
    s_lshl_b32 s39, s34, 4
    s_add_u32 s39, s39, 36096
    v_lshl_add_u32 v29, v3, 2, s39
    v_lshl_add_u32 v29, v18, 6, v29
    v_lshlrev_b32 v30, 4, v17
    v_add_u32 v30, 36096, v30
    s_mul_i32 s39, s34, 320
    s_add_u32 s39, s39, 34816
    v_and_b32 v12, 1, v3
    v_and_b32 v13, 1, v1
    v_lshl_add_u32 v12, v13, 1, v12
    v_lshrrev_b32 v19, 1, v2
    v_lshl_add_u32 v12, v19, 3, v12
    v_lshl_add_u32 v25, v12, 2, s39
    v_and_b32 v19, 3, v19
    v_mul_u32_u24 v12, 320, v19
    v_lshl_add_u32 v13, v3, 1, v13
    v_lshl_add_u32 v12, v13, 4, v12
    v_add_u32 v26, 34816, v12
    v_mul_u32_u24 v12, 4128, v18
    v_lshl_add_u32 v12, v3, 8, v12
    v_lshl_add_u32 v12, v17, 3, v12
    s_lshl_b32 s39, s34, 6
    v_lshlrev_b32 v16, 4, v16
    v_xor_b32 v16, s39, v16
    v_add_u32 v27, v16, v12
    v_mov_b32 v127, s40
    s_mov_b32 s8, 0x000f000f
    s_mov_b32 s9, 0x000f000f
    v_mov_b32 v108, 0
    v_mov_b32 v109, 0
    v_mov_b32 v110, 0
    v_mov_b32 v111, 0
    v_mov_b32 v112, 0
    v_mov_b32 v113, 0
    v_mov_b32 v114, 0
    v_mov_b32 v115, 0
    v_and_b32 v31, 1, v1
    v_mul_u32_u24 v31, 0xaaaa, v31
    v_add_u32 v31, 0x4444, v31
    s_mov_b32 s39, 0x9e3779b1
    s_mov_b32 s98, 0xaaaaaaaa
    s_mov_b32 s99, 0xaaaaaaaa
    s_mov_b32 s100, 0xcccccccc
    s_mov_b32 s101, 0xcccccccc
    v_lshl_add_u32 v164, v2, 2, 2
    v_mul_lo_u32 v164, v164, s39
    v_lshrrev_b32 v12, 15, v164
    v_xor_b32 v164, v164, v12
    v_or_b32 v164, 0x00010001, v164
    v_lshl_add_u32 v165, v2, 2, 3
    v_mul_lo_u32 v165, v165, s39
    v_lshrrev_b32 v12, 15, v165
    v_xor_b32 v165, v165, v12
    v_or_b32 v165, 0x00010001, v165
    v_lshl_add_u32 v166, v2, 2, 4
    v_mul_lo_u32 v166, v166, s39
    v_lshrrev_b32 v12, 15, v166
    v_xor_b32 v166, v166, v12
    v_or_b32 v166, 0x00010001, v166
    v_lshl_add_u32 v167, v2, 2, 5
    v_mul_lo_u32 v167, v167, s39
    v_lshrrev_b32 v12, 15, v167
    v_xor_b32 v167, v167, v12
    v_or_b32 v167, 0x00010001, v167
    s_waitcnt vmcnt(1)
    s_barrier
    ds_read_b64_tr_b16 v[128:129], v27 offset:0
    ds_read_b64_tr_b16 v[130:131], v27 offset:16512
    ds_read_b64_tr_b16 v[132:133], v27 offset:1024
    ds_read_b64_tr_b16 v[134:135], v27 offset:17536
    ds_read_b64_tr_b16 v[136:137], v27 offset:2048
    ds_read_b64_tr_b16 v[138:139], v27 offset:18560
    ds_read_b64_tr_b16 v[140:141], v27 offset:3072
    ds_read_b64_tr_b16 v[142:143], v27 offset:19584
    ds_read_b64_tr_b16 v[144:145], v27 offset:32
    ds_read_b64_tr_b16 v[146:147], v27 offset:16544
    ds_read_b64_tr_b16 v[148:149], v27 offset:1056
    ds_read_b64_tr_b16 v[150:151], v27 offset:17568
    ds_read_b64_tr_b16 v[152:153], v27 offset:2080
    ds_read_b64_tr_b16 v[154:155], v27 offset:18592
    ds_read_b64_tr_b16 v[156:157], v27 offset:3104
    ds_read_b64_tr_b16 v[158:159], v27 offset:19616
    s_waitcnt vmcnt(0)
    s_mov_b64 exec, s[8:9]
    s_mov_b32 s47, 0x1fffff
    global_load_dwordx2 v[120:121], v20, s[30:31] sc1
    s_branch L_h1_wait
L_h1_retry:
    s_sub_u32 s47, s47, 1
    s_cbranch_scc1 L_h1_done
    s_mov_b64 exec, s[54:55]
    global_load_dwordx2 v[120:121], v20, s[30:31] sc1
    s_mov_b64 exec, s[8:9]
L_h1_wait:
    s_waitcnt vmcnt(0)
    v_cmp_ne_u32 s[54:55], s40, v121
    s_cmp_lg_u64 s[54:55], 0
    s_cbranch_scc1 L_h1_retry
L_h1_done:
    s_mov_b64 exec, -1
    ds_write_b32 v23, v120
    s_waitcnt lgkmcnt(0)
    s_barrier
    ds_read_b32 v120, v24
    global_load_dwordx4 v[80:83], v21, s[30:31] offset:0 sc1
    global_load_dwordx4 v[84:87], v21, s[30:31] offset:1024 sc1
    global_load_dwordx4 v[88:91], v21, s[30:31] offset:2048 sc1
    global_load_dwordx4 v[92:95], v21, s[30:31] offset:3072 sc1
    s_mov_b64 exec, s[8:9]
    global_load_dwordx2 v[96:97], v22, s[30:31] sc1
    s_mov_b64 exec, -1
    s_waitcnt lgkmcnt(0)
    v_mov_b32 v36, v120
    s_nop 1
    v_max_f32_dpp v36, v36, v36 row_ror:8 row_mask:0xf bank_mask:0xf
    s_nop 1
    v_max_f32_dpp v36, v36, v36 row_ror:4 row_mask:0xf bank_mask:0xf
    s_nop 1
    v_max_f32_dpp v36, v36, v36 row_ror:2 row_mask:0xf bank_mask:0xf
    s_nop 1
    v_max_f32_dpp v36, v36, v36 row_ror:1 row_mask:0xf bank_mask:0xf
    v_mov_b32 v37, v36
    s_nop 1
    v_permlane16_swap_b32 v36, v37
    v_max_f32 v36, v36, v37
    v_mov_b32 v37, v36
    s_nop 1
    v_permlane32_swap_b32 v36, v37
    v_max_f32 v36, v36, v37
    v_sub_f32 v36, v120, v36
    v_mul_f32 v36, 0x3c000000, v36
    v_exp_f32 v39, v36
    s_mov_b32 s47, 0x1fffff
    v_cvt_pk_bf16_f32 v36, v39, v39
    s_nop 1
    v_and_b32_dpp v48, v36, v8 row_newbcast:0 row_mask:0xf bank_mask:0xf
    v_and_b32_dpp v49, v36, v9 row_newbcast:0 row_mask:0xf bank_mask:0xf
    v_and_b32_dpp v50, v36, v10 row_newbcast:0 row_mask:0xf bank_mask:0xf
    v_and_b32_dpp v51, v36, v11 row_newbcast:0 row_mask:0xf bank_mask:0xf
    v_and_b32_dpp v52, v36, v8 row_newbcast:1 row_mask:0xf bank_mask:0xf
    v_and_b32_dpp v53, v36, v9 row_newbcast:1 row_mask:0xf bank_mask:0xf
    v_and_b32_dpp v54, v36, v10 row_newbcast:1 row_mask:0xf bank_mask:0xf
    v_and_b32_dpp v55, v36, v11 row_newbcast:1 row_mask:0xf bank_mask:0xf
    v_and_b32_dpp v56, v36, v8 row_newbcast:2 row_mask:0xf bank_mask:0xf
    v_and_b32_dpp v57, v36, v9 row_newbcast:2 row_mask:0xf bank_mask:0xf
    v_and_b32_dpp v58, v36, v10 row_newbcast:2 row_mask:0xf bank_mask:0xf
    v_and_b32_dpp v59, v36, v11 row_newbcast:2 row_mask:0xf bank_mask:0xf
    v_and_b32_dpp v60, v36, v8 row_newbcast:3 row_mask:0xf bank_mask:0xf
    v_and_b32_dpp v61, v36, v9 row_newbcast:3 row_mask:0xf bank_mask:0xf
    v_and_b32_dpp v62, v36, v10 row_newbcast:3 row_mask:0xf bank_mask:0xf
    v_and_b32_dpp v63, v36, v11 row_newbcast:3 row_mask:0xf bank_mask:0xf
    s_barrier
    s_mov_b64 exec, s[96:97]
    global_load_dword v255, v161, s[24:25]
    s_mov_b64 exec, -1
    s_branch L_pd_go
L_pd_retry:
    s_sub_u32 s47, s47, 1
    s_cbranch_scc1 L_pd_done
    v_xor_b32 v80, s40, v80
    v_xor_b32 v84, s40, v84
    v_xor_b32 v88, s40, v88
    v_xor_b32 v92, s40, v92
    s_lshr_b64 s[10:11], s[54:55], 0
    s_and_b32 s10, s10, 0x00010001
    s_and_b32 s11, s11, 0x00010001
    s_mul_i32 exec_lo, s10, 0xffff
    s_mul_i32 exec_hi, s11, 0xffff
    s_cbranch_execz L_pd_s0
    global_load_dwordx4 v[80:83], v21, s[30:31] offset:0 sc1
L_pd_s0:
    s_lshr_b64 s[10:11], s[54:55], 1
    s_and_b32 s10, s10, 0x00010001
    s_and_b32 s11, s11, 0x00010001
    s_mul_i32 exec_lo, s10, 0xffff
    s_mul_i32 exec_hi, s11, 0xffff
    s_cbranch_execz L_pd_s1
    global_load_dwordx4 v[84:87], v21, s[30:31] offset:1024 sc1
L_pd_s1:
    s_lshr_b64 s[10:11], s[54:55], 2
    s_and_b32 s10, s10, 0x00010001
    s_and_b32 s11, s11, 0x00010001
    s_mul_i32 exec_lo, s10, 0xffff
    s_mul_i32 exec_hi, s11, 0xffff
    s_cbranch_execz L_pd_s2
    global_load_dwordx4 v[88:91], v21, s[30:31] offset:2048 sc1
L_pd_s2:
    s_lshr_b64 s[10:11], s[54:55], 3
    s_and_b32 s10, s10, 0x00010001
    s_and_b32 s11, s11, 0x00010001
    s_mul_i32 exec_lo, s10, 0xffff
    s_mul_i32 exec_hi, s11, 0xffff
    s_cbranch_execz L_pd_s3
    global_load_dwordx4 v[92:95], v21, s[30:31] offset:3072 sc1
L_pd_s3:
    s_mov_b64 exec, s[54:55]
    global_load_dwordx2 v[96:97], v22, s[30:31] sc1
    s_mov_b64 exec, -1
    s_waitcnt vmcnt(0)
L_pd_go:
    s_waitcnt vmcnt(5)
    v_xor_b32 v80, s40, v80
    v_dot2_u32_u16 v100, v80, v164, 0
    v_dot2_u32_u16 v100, v81, v165, v100
    v_mfma_f32_16x16x32_bf16 v[40:43], v[48:51], v[80:83], 0
    v_dot2_u32_u16 v100, v82, v166, v100
    v_dot2_u32_u16 v100, v83, v167, v100
    s_waitcnt vmcnt(4)
    v_xor_b32 v84, s40, v84
    v_dot2_u32_u16 v101, v84, v164, 0
    v_dot2_u32_u16 v101, v85, v165, v101
    v_mfma_f32_16x16x32_bf16 v[40:43], v[52:55], v[84:87], v[40:43]
    v_dot2_u32_u16 v101, v86, v166, v101
    v_dot2_u32_u16 v101, v87, v167, v101
    s_waitcnt vmcnt(3)
    v_xor_b32 v88, s40, v88
    v_dot2_u32_u16 v102, v88, v164, 0
    v_dot2_u32_u16 v102, v89, v165, v102
    v_mfma_f32_16x16x32_bf16 v[40:43], v[56:59], v[88:91], v[40:43]
    v_dot2_u32_u16 v102, v90, v166, v102
    v_dot2_u32_u16 v102, v91, v167, v102
    s_waitcnt vmcnt(2)
    v_xor_b32 v92, s40, v92
    v_dot2_u32_u16 v103, v92, v164, 0
    v_dot2_u32_u16 v103, v93, v165, v103
    v_mfma_f32_16x16x32_bf16 v[40:43], v[60:63], v[92:95], v[40:43]
    v_dot2_u32_u16 v103, v94, v166, v103
    v_dot2_u32_u16 v103, v95, v167, v103
    s_waitcnt vmcnt(1)
    v_mul_f32 v38, v39, v97
    v_sub_u32 v34, v96, v97
    v_subrev_u32 v34, s40, v34
    v_cndmask_b32 v105, v101, v100, s[98:99]
    v_cndmask_b32 v107, v103, v102, s[98:99]
    v_cndmask_b32 v104, v100, v101, s[98:99]
    v_cndmask_b32 v106, v102, v103, s[98:99]
    v_add_f32_dpp v38, v38, v38 quad_perm:[1,0,3,2] row_mask:0xf bank_mask:0xf
    v_add_u32_dpp v104, v105, v104 quad_perm:[1,0,3,2] row_mask:0xf bank_mask:0xf
    v_add_u32_dpp v106, v107, v106 quad_perm:[1,0,3,2] row_mask:0xf bank_mask:0xf
    v_cndmask_b32 v105, v106, v104, s[100:101]
    v_cndmask_b32 v104, v104, v106, s[100:101]
    v_add_f32_dpp v38, v38, v38 quad_perm:[2,3,0,1] row_mask:0xf bank_mask:0xf
    s_nop 0
    v_add_u32_dpp v104, v105, v104 quad_perm:[2,3,0,1] row_mask:0xf bank_mask:0xf
    v_cvt_pk_bf16_f32 v32, v40, v41
    v_cvt_pk_bf16_f32 v33, v42, v43
    v_add_u32_dpp v104, v104, v104 row_ror:4 row_mask:0xf bank_mask:0xf
    ds_write2_b32 v25, v32, v33 offset1:4
    ds_write_b32 v29, v38
    v_add_u32_dpp v104, v104, v104 row_ror:8 row_mask:0xf bank_mask:0xf
    v_cmp_ne_u32 vcc, v34, v104
    s_and_b64 s[54:55], vcc, s[8:9]
    s_cbranch_scc1 L_pd_retry
L_pd_done:
    s_waitcnt lgkmcnt(0)
    s_barrier
    ds_read_b128 v[64:67], v26
    ds_read_b128 v[68:71], v26 offset:128
    ds_read_b128 v[44:47], v30
    s_waitcnt lgkmcnt(2)
    v_smfmac_f32_16x16x64_bf16 v[108:111], v[64:67], v[128:135], v31
    v_smfmac_f32_16x16x64_bf16 v[112:115], v[64:67], v[144:151], v31
    s_waitcnt lgkmcnt(1)
    v_smfmac_f32_16x16x64_bf16 v[108:111], v[68:71], v[136:143], v31
    v_smfmac_f32_16x16x64_bf16 v[112:115], v[68:71], v[152:159], v31
    s_waitcnt lgkmcnt(0)
    v_pk_add_f32 v[44:45], v[44:45], v[46:47]
    v_add_f32 v44, v44, v45
    s_nop 1
    v_add_f32_dpp v44, v44, v44 quad_perm:[1,0,3,2] row_mask:0xf bank_mask:0xf
    s_nop 1
    v_add_f32_dpp v44, v44, v44 quad_perm:[2,3,0,1] row_mask:0xf bank_mask:0xf
    v_pk_add_f32 v[108:109], v[108:109], v[110:111]
    v_rcp_f32 v44, v44
    v_pk_add_f32 v[112:113], v[112:113], v[114:115]
    v_add_f32 v108, v108, v109
    v_add_f32 v112, v112, v113
    s_nop 1
    v_permlane16_swap_b32 v108, v112
    v_add_f32 v108, v108, v112
    v_mul_f32 v108, v108, v44
    s_nop 1
    v_mov_b32_dpp v111, v108 row_shl:12 row_mask:0xf bank_mask:0xf
    v_mov_b32_dpp v109, v108 row_shl:4 row_mask:0xf bank_mask:0xf
    v_mov_b32_dpp v110, v108 row_shl:8 row_mask:0xf bank_mask:0xf
    v_perm_b32 v124, v108, v111, s41
    v_perm_b32 v125, v109, v111, s42
    v_perm_b32 v126, v110, v111, s43
    s_mov_b64 exec, 0xf000f
    global_store_dwordx4 v28, v[124:127], s[62:63]
    global_store_dwordx4 v28, v[124:127], s[30:31] sc1
    s_endpgm
L_end:
    s_endpgm
L_code_end:
.section .rodata,"a"
.p2align 6
.amdhsa_kernel sequential_preLN__compressed_kv_cla__moe_arch_mod__decode_kernel
  .amdhsa_next_free_vgpr 512
  .amdhsa_next_free_sgpr 102
  .amdhsa_accum_offset 256
  .amdhsa_group_segment_fixed_size 0
  .amdhsa_kernarg_size 112
  .amdhsa_user_sgpr_count 2
  .amdhsa_user_sgpr_kernarg_segment_ptr 1
  .amdhsa_system_sgpr_workgroup_id_x 1
.end_amdhsa_kernel
```
